```python
import torch

def _softmax(x, axis=-1):
    return torch.softmax(x, dim=axis)
def _gelu(x):
    return torch.nn.functional.gelu(x, approximate="tanh")
def _silu(x):
    return torch.nn.functional.silu(x)
def _sigmoid(x):
    return torch.sigmoid(x)
def _layernorm(x, axis=-1, eps=1e-5):
    m = x.mean(dim=axis, keepdim=True)
    v = x.var(dim=axis, keepdim=True, unbiased=False)
    return (x - m) / torch.sqrt(v + eps)
def _scatter_add(tgt, idx, src, axis=0):
    return tgt.clone().index_add_(axis, idx, src)
def _segment_sum(src, seg, n):
    out = torch.zeros((n,) + src.shape[1:], dtype=src.dtype)
    return out.index_add_(0, seg, src)
def _pad(x, pw):
    flat = tuple(v for pair in reversed(pw) for v in pair)
    return torch.nn.functional.pad(x, flat)

kernel_name = 'concat_heads__mha_block_cached__gqa_block_cached__near_ridge'

def setup_inputs():

    _w = (lambda a: (lambda t: t.to(torch.bfloat16) if t.is_floating_point() else t)(torch.as_tensor(a)))
    def _A_setup():
        B, Sq, D = 8, 96, 1024
        H, Sk, Dh = 32, 512, 128
        return {
            "x": _w((lambda *s: torch.randn(*s, dtype=torch.bfloat16) * 0.8)(B, Sq, D)),
            "k_cache": _w((lambda *s: torch.randn(*s, dtype=torch.bfloat16) * 0.8)(B, H, Sk, Dh)),
            "v_cache": _w((lambda *s: torch.randn(*s, dtype=torch.bfloat16) * 0.05)(B, H, Sk, Dh)),
            "wq": _w((lambda *s: torch.randn(*s, dtype=torch.bfloat16) * 0.8)(D, H * Dh) * (D ** -0.5)),
            "wo": _w((lambda *s: torch.randn(*s, dtype=torch.bfloat16) * 0.05)(H * Dh, D) * ((H * Dh) ** -0.5)),
        }
    _A_in = _A_setup()

    def _B_setup():
        B, Sq, D = 8, 96, 1024
        Hq, Hkv, Sk, Dh = 32, 32, 512, 128
        assert Hq % Hkv == 0, (Hq, Hkv)
        return {
            "x": _w((lambda *s: torch.randn(*s, dtype=torch.bfloat16) * 0.8)(B, Sq, D)),
            "k_cache": _w((lambda *s: torch.randn(*s, dtype=torch.bfloat16) * 0.8)(B, Hkv, Sk, Dh)),
            "v_cache": _w((lambda *s: torch.randn(*s, dtype=torch.bfloat16) * 0.05)(B, Hkv, Sk, Dh)),
            "wq": _w((lambda *s: torch.randn(*s, dtype=torch.bfloat16) * 0.8)(D, Hq * Dh) * (D ** -0.5)),
            "wo": _w((lambda *s: torch.randn(*s, dtype=torch.bfloat16) * 0.05)(Hq * Dh, D) * ((Hq * Dh) ** -0.5)),
        }
    _B_in = _B_setup()

    return {
        "A_x": _A_in["x"],
        "A_k_cache": _A_in["k_cache"],
        "A_v_cache": _A_in["v_cache"],
        "A_wq": _A_in["wq"],
        "A_wo": _A_in["wo"],
        "B_x": _B_in["x"],
        "B_k_cache": _B_in["k_cache"],
        "B_v_cache": _B_in["v_cache"],
        "B_wq": _B_in["wq"],
        "B_wo": _B_in["wo"],
    }

def reference(A_x, A_k_cache, A_v_cache, A_wq, A_wo, B_x, B_k_cache, B_v_cache, B_wq, B_wo):
    def _A_ref(x, k_cache, v_cache, wq, wo):
        B, Sq, D = x.shape
        H, Dh = 32, 128
        q = (lambda x, *d: x.permute(*d))((x @ wq).reshape(B, Sq, H, Dh), 0, 2, 1, 3)
        scores = torch.einsum("bhqd,bhkd->bhqk", q, k_cache) * (Dh ** -0.5)
        p = _softmax(scores, axis=-1)
        o = torch.einsum("bhqk,bhkd->bhqd", p, v_cache)
        return (lambda x, *d: x.permute(*d))(o, 0, 2, 1, 3).reshape(B, Sq, H * Dh) @ wo

    def _B_ref(x, k_cache, v_cache, wq, wo):
        B, Sq, D = x.shape
        Hq, Dh = 32, 128
        Hkv = k_cache.shape[1]
        rep = Hq // Hkv
        q = (lambda x, *d: x.permute(*d))((x @ wq).reshape(B, Sq, Hq, Dh), 0, 2, 1, 3)
        k = (lambda x, n, axis: torch.repeat_interleave(x, n, dim=axis))(k_cache, rep, axis=1)
        v = (lambda x, n, axis: torch.repeat_interleave(x, n, dim=axis))(v_cache, rep, axis=1)
        scores = torch.einsum("bhqd,bhkd->bhqk", q, k) * (Dh ** -0.5)
        p = _softmax(scores, axis=-1)
        o = torch.einsum("bhqk,bhkd->bhqd", p, v)
        return (lambda x, *d: x.permute(*d))(o, 0, 2, 1, 3).reshape(B, Sq, Hq * Dh) @ wo

    a = _A_ref(A_x, A_k_cache, A_v_cache, A_wq, A_wo)
    b = _B_ref(B_x, B_k_cache, B_v_cache, B_wq, B_wo)
    return torch.concatenate([a, b], axis=-1)
```

```asm
; @launch grid=(256,1,1) block=(512,1,1) lds=163840
.amdgcn_target "amdgcn-amd-amdhsa--gfx950"
.text
.globl concat_heads__mha_block_cached__gqa_block_cached__near_ridge_kernel
.p2align 8
.type concat_heads__mha_block_cached__gqa_block_cached__near_ridge_kernel,@function
concat_heads__mha_block_cached__gqa_block_cached__near_ridge_kernel:
    s_cmp_ge_u32 s2, 256
    s_cbranch_scc1 L_end_k
    s_load_dwordx16 s[4:19], s[0:1], 0
    s_load_dwordx8 s[20:27], s[0:1], 64
    s_load_dwordx2 s[28:29], s[0:1], 96
    v_lshrrev_b32 v2, 6, v0
    v_and_b32 v1, 63, v0
    v_readfirstlane_b32 s52, v2
    s_bfe_u32 s53, s2, 0x10002
    s_and_b32 s54, s2, 3
    s_bfe_u32 s55, s2, 0x30003
    s_lshr_b32 s56, s2, 6
    s_cmp_lt_u32 s52, 4
    s_cbranch_scc1 L_compute
L_k_loader:
    s_sub_u32 s59, s52, 4
    v_lshrrev_b32 v22, 4, v1
    v_and_b32 v23, 15, v1
    s_lshr_b32 s57, s59, 1
    s_lshl_b32 s57, s57, 5
    s_and_b32 s58, s59, 1
    s_lshl_b32 s58, s58, 2
    s_add_u32 s57, s57, s58
    v_or_b32 v24, 0, v22
    v_lshlrev_b32 v24, 1, v24
    v_xor_b32 v24, v24, v23
    v_lshlrev_b32 v24, 4, v24
    v_add_u32 v4, s57, v22
    v_lshl_add_u32 v4, v4, 13, v24
    v_or_b32 v24, 4, v22
    v_lshlrev_b32 v24, 1, v24
    v_xor_b32 v24, v24, v23
    v_lshlrev_b32 v24, 4, v24
    v_add_u32 v5, s57, v22
    v_lshl_add_u32 v5, v5, 13, v24
    v_add_u32 v5, 64512, v5
    v_add_u32 v6, 129024, v4
    v_add_u32 v7, 129024, v5
    s_mul_i32 s66, s54, 4
    s_add_u32 s66, s66, s55
    s_and_b32 s57, s55, 4
    s_mul_i32 s57, s57, 3
    s_add_u32 s66, s66, s57
    s_lshl_b32 s63, s66, 8
    s_add_u32 s60, s56, s55
    s_mul_i32 s57, s60, 86
    s_lshr_b32 s57, s57, 8
    s_mul_i32 s57, s57, 3
    s_sub_u32 s60, s60, s57
    s_lshl_b32 s60, s60, 3
    s_lshr_b32 s60, 722176, s60
    s_and_b32 s60, s60, 0xff
    s_add_u32 s62, s60, 0
    s_and_b32 s62, s62, 15
    s_lshl_b32 s76, s59, 12
    s_mul_i32 s77, s59, 6144
    s_add_u32 s77, s77, 16384
    s_waitcnt lgkmcnt(0)
    s_cmp_eq_u32 s53, 0
    s_cselect_b64 s[10:11], s[10:11], s[20:21]
    s_mov_b32 s36, s10
    s_and_b32 s37, s11, 0xffff
    s_mov_b32 s38, 8388608
    s_mov_b32 s39, 0x20000
    s_mul_i32 s57, s62, 524288
    s_add_u32 m0, s76, 0
    s_add_u32 s57, s57, s63
    buffer_load_dwordx4 v4, s[36:39], s57 offen offset:0 lds
    buffer_load_dwordx4 v5, s[36:39], s57 offen offset:1024 lds
    buffer_load_dwordx4 v6, s[36:39], s57 offen offset:2048 lds
    buffer_load_dwordx4 v7, s[36:39], s57 offen offset:3072 lds
    s_mul_i32 s64, s56, 393216
    s_mul_i32 s57, s59, 48
    v_add_u32 v24, 0, v22
    v_xor_b32 v24, v24, v1
    v_and_b32 v24, 7, v24
    v_lshlrev_b32 v24, 4, v24
    v_lshrrev_b32 v8, 3, v1
    v_add_u32 v8, s57, v8
    v_lshl_add_u32 v8, v8, 11, v24
    v_add_u32 v24, 4, v22
    v_xor_b32 v24, v24, v1
    v_and_b32 v24, 7, v24
    v_lshlrev_b32 v24, 4, v24
    v_lshrrev_b32 v9, 3, v1
    v_add_u32 v9, s57, v9
    v_lshl_add_u32 v9, v9, 11, v24
    v_add_u32 v13, 80896, v9
    v_add_u32 v12, 65536, v8
    v_add_u32 v11, 46080, v9
    v_add_u32 v10, 30720, v8
    v_add_u32 v9, 15360, v9
    s_waitcnt lgkmcnt(0)
    s_cmp_eq_u32 s53, 0
    s_cselect_b64 s[4:5], s[4:5], s[14:15]
    s_cselect_b64 s[6:7], s[6:7], s[16:17]
    s_cselect_b64 s[8:9], s[8:9], s[18:19]
    s_cselect_b64 s[10:11], s[10:11], s[20:21]
    s_cselect_b64 s[12:13], s[12:13], s[22:23]
    s_mov_b32 s32, s4
    s_and_b32 s33, s5, 0xffff
    s_mov_b32 s34, 1572864
    s_mov_b32 s35, 0x20000
    s_mul_i32 s58, s62, 128
    s_add_u32 m0, s77, 0
    s_add_u32 s58, s58, s64
    buffer_load_dwordx4 v8, s[32:35], s58 offen offset:0 lds
    buffer_load_dwordx4 v9, s[32:35], s58 offen offset:1024 lds
    buffer_load_dwordx4 v10, s[32:35], s58 offen offset:2048 lds
    buffer_load_dwordx4 v11, s[32:35], s58 offen offset:3072 lds
    s_add_u32 m0, s77, 4096
    s_nop 0
    buffer_load_dwordx4 v12, s[32:35], s58 offen offset:0 lds
    buffer_load_dwordx4 v13, s[32:35], s58 offen offset:1024 lds
    s_lshl_b32 s67, s56, 3
    s_lshr_b32 s67, 100925952, s67
    s_and_b32 s67, s67, 0xff
    s_add_u32 s67, s67, s55
    s_and_b32 s67, s67, 7
    s_mov_b32 s79, 0x100000
    s_mov_b32 s40, s6
    s_and_b32 s41, s7, 0xffff
    s_mov_b32 s42, 33554432
    s_mov_b32 s43, 0x20000
    s_mov_b32 s44, s8
    s_and_b32 s45, s9, 0xffff
    s_mov_b32 s46, 33554432
    s_mov_b32 s47, 0x20000
    s_mov_b32 s48, s28
    s_and_b32 s49, s29, 0xffff
    s_mov_b32 s50, 268435456
    s_mov_b32 s51, 0x20000
    s_mov_b32 s72, s26
    s_and_b32 s73, s27, 0xffff
    s_mov_b32 s74, 256
    s_mov_b32 s75, 0x20000
    v_or_b32 v24, 0, v22
    v_lshlrev_b32 v24, 1, v24
    v_xor_b32 v24, v24, v23
    v_lshlrev_b32 v24, 4, v24
    v_lshl_add_u32 v18, v22, 8, v24
    v_or_b32 v24, 4, v22
    v_lshlrev_b32 v24, 1, v24
    v_xor_b32 v24, v24, v23
    v_lshlrev_b32 v24, 4, v24
    v_lshl_add_u32 v19, v22, 8, v24
    s_lshl_b32 s65, s59, 13
    v_lshl_add_u32 v20, v1, 4, s65
    v_add_u32 v26, 65536, v20
    s_lshl_b32 s57, s56, 1
    s_lshr_b32 s58, s59, 1
    s_add_u32 s57, s57, s58
    s_lshl_b32 s57, s57, 5
    s_add_u32 s66, s66, s57
    s_lshl_b32 s66, s66, 17
    s_and_b32 s57, s59, 1
    s_lshl_b32 s57, s57, 13
    s_add_u32 s66, s66, s57
    s_lshl_b32 s57, s55, 2
    s_mul_i32 s58, s58, 5
    s_xor_b32 s57, s57, s58
    s_lshl_b32 s57, s57, 12
    s_xor_b32 s66, s66, s57
    v_or_b32 v24, 0, v22
    v_xor_b32 v24, v24, v23
    v_lshlrev_b32 v24, 4, v24
    v_lshl_add_u32 v14, v22, 8, v24
    v_or_b32 v24, 4, v22
    v_xor_b32 v24, v24, v23
    v_lshlrev_b32 v24, 4, v24
    v_lshl_add_u32 v15, v22, 8, v24
    v_or_b32 v24, 8, v22
    v_xor_b32 v24, v24, v23
    v_lshlrev_b32 v24, 4, v24
    v_lshl_add_u32 v16, v22, 8, v24
    v_or_b32 v24, 12, v22
    v_xor_b32 v24, v24, v23
    v_lshlrev_b32 v24, 4, v24
    v_lshl_add_u32 v17, v22, 8, v24
    s_getpc_b64 s[68:69]
L_pc:
    s_lshl_b32 s57, s55, 2
    s_add_u32 s57, s57, s59
    s_lshl_b32 s57, s57, 10
    s_sub_u32 s68, s68, L_pc-concat_heads__mha_block_cached__gqa_block_cached__near_ridge_kernel
    s_subb_u32 s69, s69, 0
    v_lshl_add_u32 v30, v1, 4, s57
    v_min_u32 v30, L_last-concat_heads__mha_block_cached__gqa_block_cached__near_ridge_kernel, v30
    v_mov_b32 v31, s69
    v_add_co_u32 v30, vcc, s68, v30
    s_nop 1
    v_addc_co_u32 v31, vcc, 0, v31, vcc
    s_and_b32 s61, s55, 3
    s_add_u32 s62, s60, 1
    s_and_b32 s62, s62, 15
    s_mul_i32 s57, s62, 524288
    s_add_u32 m0, s76, 40960
    s_add_u32 s57, s57, s63
    buffer_load_dwordx4 v4, s[36:39], s57 offen offset:0 lds
    buffer_load_dwordx4 v5, s[36:39], s57 offen offset:1024 lds
    buffer_load_dwordx4 v6, s[36:39], s57 offen offset:2048 lds
    buffer_load_dwordx4 v7, s[36:39], s57 offen offset:3072 lds
    s_mul_i32 s58, s62, 128
    s_add_u32 m0, s77, 40960
    s_add_u32 s58, s58, s64
    buffer_load_dwordx4 v8, s[32:35], s58 offen offset:0 lds
    buffer_load_dwordx4 v9, s[32:35], s58 offen offset:1024 lds
    buffer_load_dwordx4 v10, s[32:35], s58 offen offset:2048 lds
    buffer_load_dwordx4 v11, s[32:35], s58 offen offset:3072 lds
    s_add_u32 m0, s77, 45056
    s_nop 0
    buffer_load_dwordx4 v12, s[32:35], s58 offen offset:0 lds
    buffer_load_dwordx4 v13, s[32:35], s58 offen offset:1024 lds
    s_waitcnt vmcnt(10)
    s_barrier
    s_cmp_lg_u32 s56, 0
    s_cbranch_scc1 2
    global_load_dword v0, v[30:31], off
    s_add_u32 s62, s60, 2
    s_and_b32 s62, s62, 15
    s_mul_i32 s57, s62, 524288
    s_add_u32 m0, s76, 81920
    s_add_u32 s57, s57, s63
    buffer_load_dwordx4 v4, s[36:39], s57 offen offset:0 lds
    buffer_load_dwordx4 v5, s[36:39], s57 offen offset:1024 lds
    buffer_load_dwordx4 v6, s[36:39], s57 offen offset:2048 lds
    buffer_load_dwordx4 v7, s[36:39], s57 offen offset:3072 lds
    s_mul_i32 s58, s62, 128
    s_add_u32 m0, s77, 81920
    s_add_u32 s58, s58, s64
    buffer_load_dwordx4 v8, s[32:35], s58 offen offset:0 lds
    buffer_load_dwordx4 v9, s[32:35], s58 offen offset:1024 lds
    buffer_load_dwordx4 v10, s[32:35], s58 offen offset:2048 lds
    buffer_load_dwordx4 v11, s[32:35], s58 offen offset:3072 lds
    s_add_u32 m0, s77, 86016
    s_nop 0
    buffer_load_dwordx4 v12, s[32:35], s58 offen offset:0 lds
    buffer_load_dwordx4 v13, s[32:35], s58 offen offset:1024 lds
    s_bitcmp0_b32 5, s61
    s_cbranch_scc1 L_nb1_0
    s_xor_b32 s57, s66, 0
    buffer_load_dwordx4 v[32:35], v14, s[40:43], s57 offen offset:0 nt
    buffer_load_dwordx4 v[36:39], v15, s[40:43], s57 offen offset:1024 nt
    buffer_load_dwordx4 v[40:43], v16, s[40:43], s57 offen offset:2048 nt
    buffer_load_dwordx4 v[44:47], v17, s[40:43], s57 offen offset:3072 nt
    s_xor_b32 s57, s66, 16384
    buffer_load_dwordx4 v[48:51], v14, s[40:43], s57 offen offset:0 nt
    buffer_load_dwordx4 v[52:55], v15, s[40:43], s57 offen offset:1024 nt
    buffer_load_dwordx4 v[56:59], v16, s[40:43], s57 offen offset:2048 nt
    buffer_load_dwordx4 v[60:63], v17, s[40:43], s57 offen offset:3072 nt
L_nb1_0:
    s_waitcnt vmcnt(10)
    s_barrier
    s_add_u32 s62, s60, 3
    s_and_b32 s62, s62, 15
    s_mul_i32 s57, s62, 524288
    s_add_u32 m0, s76, 122880
    s_add_u32 s57, s57, s63
    buffer_load_dwordx4 v4, s[36:39], s57 offen offset:0 lds
    buffer_load_dwordx4 v5, s[36:39], s57 offen offset:1024 lds
    buffer_load_dwordx4 v6, s[36:39], s57 offen offset:2048 lds
    buffer_load_dwordx4 v7, s[36:39], s57 offen offset:3072 lds
    s_mul_i32 s58, s62, 128
    s_add_u32 m0, s77, 122880
    s_add_u32 s58, s58, s64
    buffer_load_dwordx4 v8, s[32:35], s58 offen offset:0 lds
    buffer_load_dwordx4 v9, s[32:35], s58 offen offset:1024 lds
    buffer_load_dwordx4 v10, s[32:35], s58 offen offset:2048 lds
    buffer_load_dwordx4 v11, s[32:35], s58 offen offset:3072 lds
    s_add_u32 m0, s77, 126976
    s_nop 0
    buffer_load_dwordx4 v12, s[32:35], s58 offen offset:0 lds
    buffer_load_dwordx4 v13, s[32:35], s58 offen offset:1024 lds
    s_bitcmp0_b32 2, s61
    s_cbranch_scc1 L_nb2_0
    s_xor_b32 s57, s66, 0
    buffer_load_dwordx4 v[32:35], v14, s[40:43], s57 offen offset:0 nt
    buffer_load_dwordx4 v[36:39], v15, s[40:43], s57 offen offset:1024 nt
    buffer_load_dwordx4 v[40:43], v16, s[40:43], s57 offen offset:2048 nt
    buffer_load_dwordx4 v[44:47], v17, s[40:43], s57 offen offset:3072 nt
    s_xor_b32 s57, s66, 16384
    buffer_load_dwordx4 v[48:51], v14, s[40:43], s57 offen offset:0 nt
    buffer_load_dwordx4 v[52:55], v15, s[40:43], s57 offen offset:1024 nt
    buffer_load_dwordx4 v[56:59], v16, s[40:43], s57 offen offset:2048 nt
    buffer_load_dwordx4 v[60:63], v17, s[40:43], s57 offen offset:3072 nt
L_nb2_0:
    s_waitcnt vmcnt(10)
    s_barrier
    s_add_u32 s62, s60, 4
    s_and_b32 s62, s62, 15
    s_mul_i32 s57, s62, 524288
    s_add_u32 m0, s76, 0
    s_add_u32 s57, s57, s63
    buffer_load_dwordx4 v4, s[36:39], s57 offen offset:0 lds
    buffer_load_dwordx4 v5, s[36:39], s57 offen offset:1024 lds
    buffer_load_dwordx4 v6, s[36:39], s57 offen offset:2048 lds
    buffer_load_dwordx4 v7, s[36:39], s57 offen offset:3072 lds
    s_mul_i32 s58, s62, 128
    s_add_u32 m0, s77, 0
    s_add_u32 s58, s58, s64
    buffer_load_dwordx4 v8, s[32:35], s58 offen offset:0 lds
    buffer_load_dwordx4 v9, s[32:35], s58 offen offset:1024 lds
    buffer_load_dwordx4 v10, s[32:35], s58 offen offset:2048 lds
    buffer_load_dwordx4 v11, s[32:35], s58 offen offset:3072 lds
    s_add_u32 m0, s77, 4096
    s_nop 0
    buffer_load_dwordx4 v12, s[32:35], s58 offen offset:0 lds
    buffer_load_dwordx4 v13, s[32:35], s58 offen offset:1024 lds
    s_bitcmp0_b32 8, s61
    s_cbranch_scc1 L_nb3_0
    s_xor_b32 s57, s66, 0
    buffer_load_dwordx4 v[32:35], v14, s[40:43], s57 offen offset:0 nt
    buffer_load_dwordx4 v[36:39], v15, s[40:43], s57 offen offset:1024 nt
    buffer_load_dwordx4 v[40:43], v16, s[40:43], s57 offen offset:2048 nt
    buffer_load_dwordx4 v[44:47], v17, s[40:43], s57 offen offset:3072 nt
    s_xor_b32 s57, s66, 16384
    buffer_load_dwordx4 v[48:51], v14, s[40:43], s57 offen offset:0 nt
    buffer_load_dwordx4 v[52:55], v15, s[40:43], s57 offen offset:1024 nt
    buffer_load_dwordx4 v[56:59], v16, s[40:43], s57 offen offset:2048 nt
    buffer_load_dwordx4 v[60:63], v17, s[40:43], s57 offen offset:3072 nt
L_nb3_0:
    s_waitcnt vmcnt(10)
    s_barrier
    s_add_u32 s62, s60, 5
    s_and_b32 s62, s62, 15
    s_mul_i32 s57, s62, 524288
    s_add_u32 m0, s76, 40960
    s_add_u32 s57, s57, s63
    buffer_load_dwordx4 v4, s[36:39], s57 offen offset:0 lds
    buffer_load_dwordx4 v5, s[36:39], s57 offen offset:1024 lds
    buffer_load_dwordx4 v6, s[36:39], s57 offen offset:2048 lds
    buffer_load_dwordx4 v7, s[36:39], s57 offen offset:3072 lds
    s_mul_i32 s58, s62, 128
    s_add_u32 m0, s77, 40960
    s_add_u32 s58, s58, s64
    buffer_load_dwordx4 v8, s[32:35], s58 offen offset:0 lds
    buffer_load_dwordx4 v9, s[32:35], s58 offen offset:1024 lds
    buffer_load_dwordx4 v10, s[32:35], s58 offen offset:2048 lds
    buffer_load_dwordx4 v11, s[32:35], s58 offen offset:3072 lds
    s_add_u32 m0, s77, 45056
    s_nop 0
    buffer_load_dwordx4 v12, s[32:35], s58 offen offset:0 lds
    buffer_load_dwordx4 v13, s[32:35], s58 offen offset:1024 lds
    s_bitcmp0_b32 1, s61
    s_cbranch_scc1 L_nb4_1
    s_xor_b32 s57, s66, 32768
    buffer_load_dwordx4 v[64:67], v14, s[40:43], s57 offen offset:0 nt
    buffer_load_dwordx4 v[68:71], v15, s[40:43], s57 offen offset:1024 nt
    buffer_load_dwordx4 v[72:75], v16, s[40:43], s57 offen offset:2048 nt
    buffer_load_dwordx4 v[76:79], v17, s[40:43], s57 offen offset:3072 nt
    s_xor_b32 s57, s66, 49152
    buffer_load_dwordx4 v[80:83], v14, s[40:43], s57 offen offset:0 nt
    buffer_load_dwordx4 v[84:87], v15, s[40:43], s57 offen offset:1024 nt
    buffer_load_dwordx4 v[88:91], v16, s[40:43], s57 offen offset:2048 nt
    buffer_load_dwordx4 v[92:95], v17, s[40:43], s57 offen offset:3072 nt
L_nb4_1:
    s_waitcnt vmcnt(10)
    s_barrier
    s_add_u32 s62, s60, 6
    s_and_b32 s62, s62, 15
    s_mul_i32 s57, s62, 524288
    s_add_u32 m0, s76, 81920
    s_add_u32 s57, s57, s63
    buffer_load_dwordx4 v4, s[36:39], s57 offen offset:0 lds
    buffer_load_dwordx4 v5, s[36:39], s57 offen offset:1024 lds
    buffer_load_dwordx4 v6, s[36:39], s57 offen offset:2048 lds
    buffer_load_dwordx4 v7, s[36:39], s57 offen offset:3072 lds
    s_mul_i32 s58, s62, 128
    s_add_u32 m0, s77, 81920
    s_add_u32 s58, s58, s64
    buffer_load_dwordx4 v8, s[32:35], s58 offen offset:0 lds
    buffer_load_dwordx4 v9, s[32:35], s58 offen offset:1024 lds
    buffer_load_dwordx4 v10, s[32:35], s58 offen offset:2048 lds
    buffer_load_dwordx4 v11, s[32:35], s58 offen offset:3072 lds
    s_add_u32 m0, s77, 86016
    s_nop 0
    buffer_load_dwordx4 v12, s[32:35], s58 offen offset:0 lds
    buffer_load_dwordx4 v13, s[32:35], s58 offen offset:1024 lds
    s_bitcmp0_b32 2, s61
    s_cbranch_scc1 L_nb5_1
    s_xor_b32 s57, s66, 32768
    buffer_load_dwordx4 v[64:67], v14, s[40:43], s57 offen offset:0 nt
    buffer_load_dwordx4 v[68:71], v15, s[40:43], s57 offen offset:1024 nt
    buffer_load_dwordx4 v[72:75], v16, s[40:43], s57 offen offset:2048 nt
    buffer_load_dwordx4 v[76:79], v17, s[40:43], s57 offen offset:3072 nt
    s_xor_b32 s57, s66, 49152
    buffer_load_dwordx4 v[80:83], v14, s[40:43], s57 offen offset:0 nt
    buffer_load_dwordx4 v[84:87], v15, s[40:43], s57 offen offset:1024 nt
    buffer_load_dwordx4 v[88:91], v16, s[40:43], s57 offen offset:2048 nt
    buffer_load_dwordx4 v[92:95], v17, s[40:43], s57 offen offset:3072 nt
L_nb5_1:
    s_waitcnt vmcnt(10)
    s_barrier
    s_add_u32 s62, s60, 7
    s_and_b32 s62, s62, 15
    s_mul_i32 s57, s62, 524288
    s_add_u32 m0, s76, 122880
    s_add_u32 s57, s57, s63
    buffer_load_dwordx4 v4, s[36:39], s57 offen offset:0 lds
    buffer_load_dwordx4 v5, s[36:39], s57 offen offset:1024 lds
    buffer_load_dwordx4 v6, s[36:39], s57 offen offset:2048 lds
    buffer_load_dwordx4 v7, s[36:39], s57 offen offset:3072 lds
    s_mul_i32 s58, s62, 128
    s_add_u32 m0, s77, 122880
    s_add_u32 s58, s58, s64
    buffer_load_dwordx4 v8, s[32:35], s58 offen offset:0 lds
    buffer_load_dwordx4 v9, s[32:35], s58 offen offset:1024 lds
    buffer_load_dwordx4 v10, s[32:35], s58 offen offset:2048 lds
    buffer_load_dwordx4 v11, s[32:35], s58 offen offset:3072 lds
    s_add_u32 m0, s77, 126976
    s_nop 0
    buffer_load_dwordx4 v12, s[32:35], s58 offen offset:0 lds
    buffer_load_dwordx4 v13, s[32:35], s58 offen offset:1024 lds
    s_bitcmp0_b32 4, s61
    s_cbranch_scc1 L_nb6_1
    s_xor_b32 s57, s66, 32768
    buffer_load_dwordx4 v[64:67], v14, s[40:43], s57 offen offset:0 nt
    buffer_load_dwordx4 v[68:71], v15, s[40:43], s57 offen offset:1024 nt
    buffer_load_dwordx4 v[72:75], v16, s[40:43], s57 offen offset:2048 nt
    buffer_load_dwordx4 v[76:79], v17, s[40:43], s57 offen offset:3072 nt
    s_xor_b32 s57, s66, 49152
    buffer_load_dwordx4 v[80:83], v14, s[40:43], s57 offen offset:0 nt
    buffer_load_dwordx4 v[84:87], v15, s[40:43], s57 offen offset:1024 nt
    buffer_load_dwordx4 v[88:91], v16, s[40:43], s57 offen offset:2048 nt
    buffer_load_dwordx4 v[92:95], v17, s[40:43], s57 offen offset:3072 nt
L_nb6_1:
    s_waitcnt vmcnt(10)
    s_barrier
    s_add_u32 s62, s60, 8
    s_and_b32 s62, s62, 15
    s_mul_i32 s57, s62, 524288
    s_add_u32 m0, s76, 0
    s_add_u32 s57, s57, s63
    buffer_load_dwordx4 v4, s[36:39], s57 offen offset:0 lds
    buffer_load_dwordx4 v5, s[36:39], s57 offen offset:1024 lds
    buffer_load_dwordx4 v6, s[36:39], s57 offen offset:2048 lds
    buffer_load_dwordx4 v7, s[36:39], s57 offen offset:3072 lds
    s_mul_i32 s58, s62, 128
    s_add_u32 m0, s77, 0
    s_add_u32 s58, s58, s64
    buffer_load_dwordx4 v8, s[32:35], s58 offen offset:0 lds
    buffer_load_dwordx4 v9, s[32:35], s58 offen offset:1024 lds
    buffer_load_dwordx4 v10, s[32:35], s58 offen offset:2048 lds
    buffer_load_dwordx4 v11, s[32:35], s58 offen offset:3072 lds
    s_add_u32 m0, s77, 4096
    s_nop 0
    buffer_load_dwordx4 v12, s[32:35], s58 offen offset:0 lds
    buffer_load_dwordx4 v13, s[32:35], s58 offen offset:1024 lds
    s_bitcmp0_b32 8, s61
    s_cbranch_scc1 L_nb7_1
    s_xor_b32 s57, s66, 32768
    buffer_load_dwordx4 v[64:67], v14, s[40:43], s57 offen offset:0 nt
    buffer_load_dwordx4 v[68:71], v15, s[40:43], s57 offen offset:1024 nt
    buffer_load_dwordx4 v[72:75], v16, s[40:43], s57 offen offset:2048 nt
    buffer_load_dwordx4 v[76:79], v17, s[40:43], s57 offen offset:3072 nt
    s_xor_b32 s57, s66, 49152
    buffer_load_dwordx4 v[80:83], v14, s[40:43], s57 offen offset:0 nt
    buffer_load_dwordx4 v[84:87], v15, s[40:43], s57 offen offset:1024 nt
    buffer_load_dwordx4 v[88:91], v16, s[40:43], s57 offen offset:2048 nt
    buffer_load_dwordx4 v[92:95], v17, s[40:43], s57 offen offset:3072 nt
L_nb7_1:
    s_bitcmp0_b32 1, s61
    s_cbranch_scc1 L_nb7_2
    s_xor_b32 s57, s66, 65536
    buffer_load_dwordx4 v[96:99], v14, s[40:43], s57 offen offset:0 nt
    buffer_load_dwordx4 v[100:103], v15, s[40:43], s57 offen offset:1024 nt
    buffer_load_dwordx4 v[104:107], v16, s[40:43], s57 offen offset:2048 nt
    buffer_load_dwordx4 v[108:111], v17, s[40:43], s57 offen offset:3072 nt
    s_xor_b32 s57, s66, 81920
    buffer_load_dwordx4 v[112:115], v14, s[40:43], s57 offen offset:0 nt
    buffer_load_dwordx4 v[116:119], v15, s[40:43], s57 offen offset:1024 nt
    buffer_load_dwordx4 v[120:123], v16, s[40:43], s57 offen offset:2048 nt
    buffer_load_dwordx4 v[124:127], v17, s[40:43], s57 offen offset:3072 nt
L_nb7_2:
    s_waitcnt vmcnt(10)
    s_barrier
    s_add_u32 s62, s60, 9
    s_and_b32 s62, s62, 15
    s_mul_i32 s57, s62, 524288
    s_add_u32 m0, s76, 40960
    s_add_u32 s57, s57, s63
    buffer_load_dwordx4 v4, s[36:39], s57 offen offset:0 lds
    buffer_load_dwordx4 v5, s[36:39], s57 offen offset:1024 lds
    buffer_load_dwordx4 v6, s[36:39], s57 offen offset:2048 lds
    buffer_load_dwordx4 v7, s[36:39], s57 offen offset:3072 lds
    s_mul_i32 s58, s62, 128
    s_add_u32 m0, s77, 40960
    s_add_u32 s58, s58, s64
    buffer_load_dwordx4 v8, s[32:35], s58 offen offset:0 lds
    buffer_load_dwordx4 v9, s[32:35], s58 offen offset:1024 lds
    buffer_load_dwordx4 v10, s[32:35], s58 offen offset:2048 lds
    buffer_load_dwordx4 v11, s[32:35], s58 offen offset:3072 lds
    s_add_u32 m0, s77, 45056
    s_nop 0
    buffer_load_dwordx4 v12, s[32:35], s58 offen offset:0 lds
    buffer_load_dwordx4 v13, s[32:35], s58 offen offset:1024 lds
    s_waitcnt vmcnt(10)
    s_barrier
    s_add_u32 s62, s60, 10
    s_and_b32 s62, s62, 15
    s_mul_i32 s57, s62, 524288
    s_add_u32 m0, s76, 81920
    s_add_u32 s57, s57, s63
    buffer_load_dwordx4 v4, s[36:39], s57 offen offset:0 lds
    buffer_load_dwordx4 v5, s[36:39], s57 offen offset:1024 lds
    buffer_load_dwordx4 v6, s[36:39], s57 offen offset:2048 lds
    buffer_load_dwordx4 v7, s[36:39], s57 offen offset:3072 lds
    s_mul_i32 s58, s62, 128
    s_add_u32 m0, s77, 81920
    s_add_u32 s58, s58, s64
    buffer_load_dwordx4 v8, s[32:35], s58 offen offset:0 lds
    buffer_load_dwordx4 v9, s[32:35], s58 offen offset:1024 lds
    buffer_load_dwordx4 v10, s[32:35], s58 offen offset:2048 lds
    buffer_load_dwordx4 v11, s[32:35], s58 offen offset:3072 lds
    s_add_u32 m0, s77, 86016
    s_nop 0
    buffer_load_dwordx4 v12, s[32:35], s58 offen offset:0 lds
    buffer_load_dwordx4 v13, s[32:35], s58 offen offset:1024 lds
    s_bitcmp0_b32 2, s61
    s_cbranch_scc1 L_nb9_2
    s_xor_b32 s57, s66, 65536
    buffer_load_dwordx4 v[96:99], v14, s[40:43], s57 offen offset:0 nt
    buffer_load_dwordx4 v[100:103], v15, s[40:43], s57 offen offset:1024 nt
    buffer_load_dwordx4 v[104:107], v16, s[40:43], s57 offen offset:2048 nt
    buffer_load_dwordx4 v[108:111], v17, s[40:43], s57 offen offset:3072 nt
    s_xor_b32 s57, s66, 81920
    buffer_load_dwordx4 v[112:115], v14, s[40:43], s57 offen offset:0 nt
    buffer_load_dwordx4 v[116:119], v15, s[40:43], s57 offen offset:1024 nt
    buffer_load_dwordx4 v[120:123], v16, s[40:43], s57 offen offset:2048 nt
    buffer_load_dwordx4 v[124:127], v17, s[40:43], s57 offen offset:3072 nt
L_nb9_2:
    s_waitcnt vmcnt(10)
    s_barrier
    s_add_u32 s62, s60, 11
    s_and_b32 s62, s62, 15
    s_mul_i32 s57, s62, 524288
    s_add_u32 m0, s76, 122880
    s_add_u32 s57, s57, s63
    buffer_load_dwordx4 v4, s[36:39], s57 offen offset:0 lds
    buffer_load_dwordx4 v5, s[36:39], s57 offen offset:1024 lds
    buffer_load_dwordx4 v6, s[36:39], s57 offen offset:2048 lds
    buffer_load_dwordx4 v7, s[36:39], s57 offen offset:3072 lds
    s_mul_i32 s58, s62, 128
    s_add_u32 m0, s77, 122880
    s_add_u32 s58, s58, s64
    buffer_load_dwordx4 v8, s[32:35], s58 offen offset:0 lds
    buffer_load_dwordx4 v9, s[32:35], s58 offen offset:1024 lds
    buffer_load_dwordx4 v10, s[32:35], s58 offen offset:2048 lds
    buffer_load_dwordx4 v11, s[32:35], s58 offen offset:3072 lds
    s_add_u32 m0, s77, 126976
    s_nop 0
    buffer_load_dwordx4 v12, s[32:35], s58 offen offset:0 lds
    buffer_load_dwordx4 v13, s[32:35], s58 offen offset:1024 lds
    s_bitcmp0_b32 12, s61
    s_cbranch_scc1 L_nb10_2
    s_xor_b32 s57, s66, 65536
    buffer_load_dwordx4 v[96:99], v14, s[40:43], s57 offen offset:0 nt
    buffer_load_dwordx4 v[100:103], v15, s[40:43], s57 offen offset:1024 nt
    buffer_load_dwordx4 v[104:107], v16, s[40:43], s57 offen offset:2048 nt
    buffer_load_dwordx4 v[108:111], v17, s[40:43], s57 offen offset:3072 nt
    s_xor_b32 s57, s66, 81920
    buffer_load_dwordx4 v[112:115], v14, s[40:43], s57 offen offset:0 nt
    buffer_load_dwordx4 v[116:119], v15, s[40:43], s57 offen offset:1024 nt
    buffer_load_dwordx4 v[120:123], v16, s[40:43], s57 offen offset:2048 nt
    buffer_load_dwordx4 v[124:127], v17, s[40:43], s57 offen offset:3072 nt
L_nb10_2:
    s_waitcnt vmcnt(10)
    s_barrier
    s_add_u32 s62, s60, 12
    s_and_b32 s62, s62, 15
    s_mul_i32 s57, s62, 524288
    s_add_u32 m0, s76, 0
    s_add_u32 s57, s57, s63
    buffer_load_dwordx4 v4, s[36:39], s57 offen offset:0 lds
    buffer_load_dwordx4 v5, s[36:39], s57 offen offset:1024 lds
    buffer_load_dwordx4 v6, s[36:39], s57 offen offset:2048 lds
    buffer_load_dwordx4 v7, s[36:39], s57 offen offset:3072 lds
    s_mul_i32 s58, s62, 128
    s_add_u32 m0, s77, 0
    s_add_u32 s58, s58, s64
    buffer_load_dwordx4 v8, s[32:35], s58 offen offset:0 lds
    buffer_load_dwordx4 v9, s[32:35], s58 offen offset:1024 lds
    buffer_load_dwordx4 v10, s[32:35], s58 offen offset:2048 lds
    buffer_load_dwordx4 v11, s[32:35], s58 offen offset:3072 lds
    s_add_u32 m0, s77, 4096
    s_nop 0
    buffer_load_dwordx4 v12, s[32:35], s58 offen offset:0 lds
    buffer_load_dwordx4 v13, s[32:35], s58 offen offset:1024 lds
    s_bitcmp0_b32 1, s61
    s_cbranch_scc1 L_nb11_3
    s_xor_b32 s57, s66, 98304
    buffer_load_dwordx4 v[128:131], v14, s[40:43], s57 offen offset:0 nt
    buffer_load_dwordx4 v[132:135], v15, s[40:43], s57 offen offset:1024 nt
    buffer_load_dwordx4 v[136:139], v16, s[40:43], s57 offen offset:2048 nt
    buffer_load_dwordx4 v[140:143], v17, s[40:43], s57 offen offset:3072 nt
    s_xor_b32 s57, s66, 114688
    buffer_load_dwordx4 v[144:147], v14, s[40:43], s57 offen offset:0 nt
    buffer_load_dwordx4 v[148:151], v15, s[40:43], s57 offen offset:1024 nt
    buffer_load_dwordx4 v[152:155], v16, s[40:43], s57 offen offset:2048 nt
    buffer_load_dwordx4 v[156:159], v17, s[40:43], s57 offen offset:3072 nt
L_nb11_3:
    s_waitcnt vmcnt(10)
    s_barrier
    s_add_u32 s62, s60, 13
    s_and_b32 s62, s62, 15
    s_mul_i32 s57, s62, 524288
    s_add_u32 m0, s76, 40960
    s_add_u32 s57, s57, s63
    buffer_load_dwordx4 v4, s[36:39], s57 offen offset:0 lds
    buffer_load_dwordx4 v5, s[36:39], s57 offen offset:1024 lds
    buffer_load_dwordx4 v6, s[36:39], s57 offen offset:2048 lds
    buffer_load_dwordx4 v7, s[36:39], s57 offen offset:3072 lds
    s_mul_i32 s58, s62, 128
    s_add_u32 m0, s77, 40960
    s_add_u32 s58, s58, s64
    buffer_load_dwordx4 v8, s[32:35], s58 offen offset:0 lds
    buffer_load_dwordx4 v9, s[32:35], s58 offen offset:1024 lds
    buffer_load_dwordx4 v10, s[32:35], s58 offen offset:2048 lds
    buffer_load_dwordx4 v11, s[32:35], s58 offen offset:3072 lds
    s_add_u32 m0, s77, 45056
    s_nop 0
    buffer_load_dwordx4 v12, s[32:35], s58 offen offset:0 lds
    buffer_load_dwordx4 v13, s[32:35], s58 offen offset:1024 lds
    s_bitcmp0_b32 2, s61
    s_cbranch_scc1 L_nb12_3
    s_xor_b32 s57, s66, 98304
    buffer_load_dwordx4 v[128:131], v14, s[40:43], s57 offen offset:0 nt
    buffer_load_dwordx4 v[132:135], v15, s[40:43], s57 offen offset:1024 nt
    buffer_load_dwordx4 v[136:139], v16, s[40:43], s57 offen offset:2048 nt
    buffer_load_dwordx4 v[140:143], v17, s[40:43], s57 offen offset:3072 nt
    s_xor_b32 s57, s66, 114688
    buffer_load_dwordx4 v[144:147], v14, s[40:43], s57 offen offset:0 nt
    buffer_load_dwordx4 v[148:151], v15, s[40:43], s57 offen offset:1024 nt
    buffer_load_dwordx4 v[152:155], v16, s[40:43], s57 offen offset:2048 nt
    buffer_load_dwordx4 v[156:159], v17, s[40:43], s57 offen offset:3072 nt
L_nb12_3:
    s_waitcnt vmcnt(10)
    s_barrier
    s_add_u32 s62, s60, 14
    s_and_b32 s62, s62, 15
    s_mul_i32 s57, s62, 524288
    s_add_u32 m0, s76, 81920
    s_add_u32 s57, s57, s63
    buffer_load_dwordx4 v4, s[36:39], s57 offen offset:0 lds
    buffer_load_dwordx4 v5, s[36:39], s57 offen offset:1024 lds
    buffer_load_dwordx4 v6, s[36:39], s57 offen offset:2048 lds
    buffer_load_dwordx4 v7, s[36:39], s57 offen offset:3072 lds
    s_mul_i32 s58, s62, 128
    s_add_u32 m0, s77, 81920
    s_add_u32 s58, s58, s64
    buffer_load_dwordx4 v8, s[32:35], s58 offen offset:0 lds
    buffer_load_dwordx4 v9, s[32:35], s58 offen offset:1024 lds
    buffer_load_dwordx4 v10, s[32:35], s58 offen offset:2048 lds
    buffer_load_dwordx4 v11, s[32:35], s58 offen offset:3072 lds
    s_add_u32 m0, s77, 86016
    s_nop 0
    buffer_load_dwordx4 v12, s[32:35], s58 offen offset:0 lds
    buffer_load_dwordx4 v13, s[32:35], s58 offen offset:1024 lds
    s_bitcmp0_b32 4, s61
    s_cbranch_scc1 L_nb13_3
    s_xor_b32 s57, s66, 98304
    buffer_load_dwordx4 v[128:131], v14, s[40:43], s57 offen offset:0 nt
    buffer_load_dwordx4 v[132:135], v15, s[40:43], s57 offen offset:1024 nt
    buffer_load_dwordx4 v[136:139], v16, s[40:43], s57 offen offset:2048 nt
    buffer_load_dwordx4 v[140:143], v17, s[40:43], s57 offen offset:3072 nt
    s_xor_b32 s57, s66, 114688
    buffer_load_dwordx4 v[144:147], v14, s[40:43], s57 offen offset:0 nt
    buffer_load_dwordx4 v[148:151], v15, s[40:43], s57 offen offset:1024 nt
    buffer_load_dwordx4 v[152:155], v16, s[40:43], s57 offen offset:2048 nt
    buffer_load_dwordx4 v[156:159], v17, s[40:43], s57 offen offset:3072 nt
L_nb13_3:
    s_waitcnt vmcnt(10)
    s_barrier
    s_add_u32 s62, s60, 15
    s_and_b32 s62, s62, 15
    s_mul_i32 s57, s62, 524288
    s_add_u32 m0, s76, 122880
    s_add_u32 s57, s57, s63
    buffer_load_dwordx4 v4, s[36:39], s57 offen offset:0 lds
    buffer_load_dwordx4 v5, s[36:39], s57 offen offset:1024 lds
    buffer_load_dwordx4 v6, s[36:39], s57 offen offset:2048 lds
    buffer_load_dwordx4 v7, s[36:39], s57 offen offset:3072 lds
    s_mul_i32 s58, s62, 128
    s_add_u32 m0, s77, 122880
    s_add_u32 s58, s58, s64
    buffer_load_dwordx4 v8, s[32:35], s58 offen offset:0 lds
    buffer_load_dwordx4 v9, s[32:35], s58 offen offset:1024 lds
    buffer_load_dwordx4 v10, s[32:35], s58 offen offset:2048 lds
    buffer_load_dwordx4 v11, s[32:35], s58 offen offset:3072 lds
    s_add_u32 m0, s77, 126976
    s_nop 0
    buffer_load_dwordx4 v12, s[32:35], s58 offen offset:0 lds
    buffer_load_dwordx4 v13, s[32:35], s58 offen offset:1024 lds
    s_bitcmp0_b32 8, s61
    s_cbranch_scc1 L_nb14_3
    s_xor_b32 s57, s66, 98304
    buffer_load_dwordx4 v[128:131], v14, s[40:43], s57 offen offset:0 nt
    buffer_load_dwordx4 v[132:135], v15, s[40:43], s57 offen offset:1024 nt
    buffer_load_dwordx4 v[136:139], v16, s[40:43], s57 offen offset:2048 nt
    buffer_load_dwordx4 v[140:143], v17, s[40:43], s57 offen offset:3072 nt
    s_xor_b32 s57, s66, 114688
    buffer_load_dwordx4 v[144:147], v14, s[40:43], s57 offen offset:0 nt
    buffer_load_dwordx4 v[148:151], v15, s[40:43], s57 offen offset:1024 nt
    buffer_load_dwordx4 v[152:155], v16, s[40:43], s57 offen offset:2048 nt
    buffer_load_dwordx4 v[156:159], v17, s[40:43], s57 offen offset:3072 nt
L_nb14_3:
L_att0:
    s_waitcnt vmcnt(10)
    s_barrier
    s_add_u32 m0, s65, 4096
    s_xor_b32 s57, s66, 4096
    buffer_load_dwordx4 v14, s[40:43], s57 offen offset:0 nt lds
    buffer_load_dwordx4 v15, s[40:43], s57 offen offset:1024 nt lds
    buffer_load_dwordx4 v16, s[40:43], s57 offen offset:2048 nt lds
    buffer_load_dwordx4 v17, s[40:43], s57 offen offset:3072 nt lds
    s_waitcnt vmcnt(4)
    ds_write_b128 v20, v[32:35] offset:0
    ds_write_b128 v20, v[36:39] offset:1024
    ds_write_b128 v20, v[40:43] offset:2048
    ds_write_b128 v20, v[44:47] offset:3072
    s_xor_b32 s57, s66, 118784
    buffer_load_dwordx4 v[160:163], v14, s[40:43], s57 offen offset:0 nt
    buffer_load_dwordx4 v[164:167], v15, s[40:43], s57 offen offset:1024 nt
    buffer_load_dwordx4 v[168:171], v16, s[40:43], s57 offen offset:2048 nt
    buffer_load_dwordx4 v[172:175], v17, s[40:43], s57 offen offset:3072 nt
    s_waitcnt vmcnt(8)
    s_barrier
    s_add_u32 m0, s65, 32768
    s_xor_b32 s57, s66, 0
    buffer_load_dwordx4 v18, s[44:47], s57 offen offset:0 nt lds
    buffer_load_dwordx4 v19, s[44:47], s57 offen offset:1024 nt lds
    buffer_load_dwordx4 v18, s[44:47], s57 offen offset:2048 nt lds
    buffer_load_dwordx4 v19, s[44:47], s57 offen offset:3072 nt lds
    s_waitcnt vmcnt(12)
    s_waitcnt lgkmcnt(0)
    s_waitcnt vmcnt(8)
    s_barrier
    s_mov_b32 s36, s12
    s_and_b32 s37, s13, 0xffff
    s_mov_b32 s38, 8388608
    s_mov_b32 s39, 0x20000
    v_lshrrev_b32 v22, 4, v1
    v_and_b32 v23, 15, v1
    s_lshl_b32 s57, s59, 4
    v_or_b32 v24, 0, v22
    v_lshlrev_b32 v24, 1, v24
    v_xor_b32 v24, v24, v23
    v_lshlrev_b32 v24, 4, v24
    v_add_u32 v4, s57, v22
    v_lshl_add_u32 v4, v4, 11, v24
    v_or_b32 v24, 4, v22
    v_lshlrev_b32 v24, 1, v24
    v_xor_b32 v24, v24, v23
    v_lshlrev_b32 v24, 4, v24
    v_add_u32 v5, s57, v22
    v_lshl_add_u32 v5, v5, 11, v24
    v_add_u32 v5, 7168, v5
    v_add_u32 v6, 14336, v4
    v_add_u32 v7, 14336, v5
    v_lshlrev_b32 v8, 4, v1
    v_lshlrev_b32 v9, 4, v1
    v_lshlrev_b32 v10, 4, v1
    v_lshlrev_b32 v11, 4, v1
    v_lshlrev_b32 v12, 4, v1
    v_add_u32 v12, 4096, v12
    v_lshlrev_b32 v13, 4, v1
    v_add_u32 v13, 4096, v13
    s_mul_i32 s63, s54, 1048576
    s_lshl_b32 s57, s67, 8
    s_add_u32 s63, s63, s57
    s_lshl_b32 s57, s53, 2
    s_add_u32 s57, s57, s56
    s_lshl_b32 s57, s57, 2
    s_add_u32 s57, s57, s59
    s_lshl_b32 s57, s57, 2
    s_add_u32 s57, s57, s54
    s_mul_i32 s64, s57, 98304
    s_add_u32 s64, s64, 0
    s_lshl_b32 s62, s55, 1
    s_and_b32 s57, s2, 0xc7
    s_lshl_b32 s57, s57, 3
    s_add_u32 s57, s57, s59
    s_lshl_b32 s57, s57, 7
    s_add_u32 s78, s57, 33554432
    v_and_b32 v21, 7, v1
    v_lshlrev_b32 v21, 13, v21
    s_add_u32 m0, s65, 36864
    s_xor_b32 s57, s66, 4096
    buffer_load_dwordx4 v18, s[44:47], s57 offen offset:0 nt lds
    buffer_load_dwordx4 v19, s[44:47], s57 offen offset:1024 nt lds
    buffer_load_dwordx4 v18, s[44:47], s57 offen offset:2048 nt lds
    buffer_load_dwordx4 v19, s[44:47], s57 offen offset:3072 nt lds
    s_waitcnt vmcnt(16)
    ds_write_b128 v26, v[48:51] offset:0
    ds_write_b128 v26, v[52:55] offset:1024
    ds_write_b128 v26, v[56:59] offset:2048
    ds_write_b128 v26, v[60:63] offset:3072
    s_add_u32 m0, s65, 69632
    s_xor_b32 s57, s66, 20480
    buffer_load_dwordx4 v14, s[40:43], s57 offen offset:0 nt lds
    buffer_load_dwordx4 v15, s[40:43], s57 offen offset:1024 nt lds
    buffer_load_dwordx4 v16, s[40:43], s57 offen offset:2048 nt lds
    buffer_load_dwordx4 v17, s[40:43], s57 offen offset:3072 nt lds
    s_waitcnt lgkmcnt(0)
    s_waitcnt vmcnt(4)
    s_barrier
    s_add_u32 m0, s65, 98304
    s_xor_b32 s57, s66, 16384
    buffer_load_dwordx4 v18, s[44:47], s57 offen offset:0 nt lds
    buffer_load_dwordx4 v19, s[44:47], s57 offen offset:1024 nt lds
    buffer_load_dwordx4 v18, s[44:47], s57 offen offset:2048 nt lds
    buffer_load_dwordx4 v19, s[44:47], s57 offen offset:3072 nt lds
    s_waitcnt vmcnt(4)
    s_barrier
    s_add_u32 m0, s65, 102400
    s_xor_b32 s57, s66, 20480
    buffer_load_dwordx4 v18, s[44:47], s57 offen offset:0 nt lds
    buffer_load_dwordx4 v19, s[44:47], s57 offen offset:1024 nt lds
    buffer_load_dwordx4 v18, s[44:47], s57 offen offset:2048 nt lds
    buffer_load_dwordx4 v19, s[44:47], s57 offen offset:3072 nt lds
    s_waitcnt vmcnt(28)
    ds_write_b128 v20, v[64:67] offset:0
    ds_write_b128 v20, v[68:71] offset:1024
    ds_write_b128 v20, v[72:75] offset:2048
    ds_write_b128 v20, v[76:79] offset:3072
    s_add_u32 m0, s65, 4096
    s_xor_b32 s57, s66, 36864
    buffer_load_dwordx4 v14, s[40:43], s57 offen offset:0 nt lds
    buffer_load_dwordx4 v15, s[40:43], s57 offen offset:1024 nt lds
    buffer_load_dwordx4 v16, s[40:43], s57 offen offset:2048 nt lds
    buffer_load_dwordx4 v17, s[40:43], s57 offen offset:3072 nt lds
    s_waitcnt lgkmcnt(0)
    s_waitcnt vmcnt(4)
    s_barrier
    s_add_u32 m0, s65, 131072
    s_xor_b32 s57, s66, 32768
    buffer_load_dwordx4 v18, s[44:47], s57 offen offset:0 nt lds
    buffer_load_dwordx4 v19, s[44:47], s57 offen offset:1024 nt lds
    buffer_load_dwordx4 v18, s[44:47], s57 offen offset:2048 nt lds
    buffer_load_dwordx4 v19, s[44:47], s57 offen offset:3072 nt lds
    s_waitcnt vmcnt(4)
    s_barrier
    s_add_u32 m0, s65, 135168
    s_xor_b32 s57, s66, 36864
    buffer_load_dwordx4 v18, s[44:47], s57 offen offset:0 nt lds
    buffer_load_dwordx4 v19, s[44:47], s57 offen offset:1024 nt lds
    buffer_load_dwordx4 v18, s[44:47], s57 offen offset:2048 nt lds
    buffer_load_dwordx4 v19, s[44:47], s57 offen offset:3072 nt lds
    s_waitcnt vmcnt(40)
    ds_write_b128 v26, v[80:83] offset:0
    ds_write_b128 v26, v[84:87] offset:1024
    ds_write_b128 v26, v[88:91] offset:2048
    ds_write_b128 v26, v[92:95] offset:3072
    s_add_u32 m0, s65, 69632
    s_xor_b32 s57, s66, 53248
    buffer_load_dwordx4 v14, s[40:43], s57 offen offset:0 nt lds
    buffer_load_dwordx4 v15, s[40:43], s57 offen offset:1024 nt lds
    buffer_load_dwordx4 v16, s[40:43], s57 offen offset:2048 nt lds
    buffer_load_dwordx4 v17, s[40:43], s57 offen offset:3072 nt lds
    s_waitcnt lgkmcnt(0)
    s_waitcnt vmcnt(4)
    s_barrier
    s_add_u32 m0, s65, 32768
    s_xor_b32 s57, s66, 49152
    buffer_load_dwordx4 v18, s[44:47], s57 offen offset:0 nt lds
    buffer_load_dwordx4 v19, s[44:47], s57 offen offset:1024 nt lds
    buffer_load_dwordx4 v18, s[44:47], s57 offen offset:2048 nt lds
    buffer_load_dwordx4 v19, s[44:47], s57 offen offset:3072 nt lds
    s_waitcnt vmcnt(4)
    s_barrier
    s_cmp_lg_u32 s56, 0
    s_cbranch_scc1 2
    global_load_dword v0, v[30:31], off
    s_add_u32 m0, s65, 36864
    s_xor_b32 s57, s66, 53248
    buffer_load_dwordx4 v18, s[44:47], s57 offen offset:0 nt lds
    buffer_load_dwordx4 v19, s[44:47], s57 offen offset:1024 nt lds
    buffer_load_dwordx4 v18, s[44:47], s57 offen offset:2048 nt lds
    buffer_load_dwordx4 v19, s[44:47], s57 offen offset:3072 nt lds
    s_waitcnt vmcnt(52)
    ds_write_b128 v20, v[96:99] offset:0
    ds_write_b128 v20, v[100:103] offset:1024
    ds_write_b128 v20, v[104:107] offset:2048
    ds_write_b128 v20, v[108:111] offset:3072
    s_add_u32 m0, s65, 4096
    s_xor_b32 s57, s66, 69632
    buffer_load_dwordx4 v14, s[40:43], s57 offen offset:0 nt lds
    buffer_load_dwordx4 v15, s[40:43], s57 offen offset:1024 nt lds
    buffer_load_dwordx4 v16, s[40:43], s57 offen offset:2048 nt lds
    buffer_load_dwordx4 v17, s[40:43], s57 offen offset:3072 nt lds
    s_waitcnt lgkmcnt(0)
    s_waitcnt vmcnt(4)
    s_barrier
    s_add_u32 m0, s65, 98304
    s_xor_b32 s57, s66, 65536
    buffer_load_dwordx4 v18, s[44:47], s57 offen offset:0 nt lds
    buffer_load_dwordx4 v19, s[44:47], s57 offen offset:1024 nt lds
    buffer_load_dwordx4 v18, s[44:47], s57 offen offset:2048 nt lds
    buffer_load_dwordx4 v19, s[44:47], s57 offen offset:3072 nt lds
    s_waitcnt vmcnt(4)
    s_barrier
    s_lshl1_add_u32 s71, s56, s53
    s_lshl_b32 s71, s71, 5
    v_xor_b32 v27, s54, v1
    v_and_b32 v27, 3, v27
    v_lshlrev_b32 v27, 3, v27
    buffer_load_dword v25, v27, s[72:75], s71 offen sc1
    s_add_u32 m0, s65, 102400
    s_xor_b32 s57, s66, 69632
    buffer_load_dwordx4 v18, s[44:47], s57 offen offset:0 nt lds
    buffer_load_dwordx4 v19, s[44:47], s57 offen offset:1024 nt lds
    buffer_load_dwordx4 v18, s[44:47], s57 offen offset:2048 nt lds
    buffer_load_dwordx4 v19, s[44:47], s57 offen offset:3072 nt lds
    s_waitcnt vmcnt(63)
    ds_write_b128 v26, v[112:115] offset:0
    ds_write_b128 v26, v[116:119] offset:1024
    ds_write_b128 v26, v[120:123] offset:2048
    ds_write_b128 v26, v[124:127] offset:3072
    s_add_u32 m0, s65, 69632
    s_xor_b32 s57, s66, 86016
    buffer_load_dwordx4 v14, s[40:43], s57 offen offset:0 nt lds
    buffer_load_dwordx4 v15, s[40:43], s57 offen offset:1024 nt lds
    buffer_load_dwordx4 v16, s[40:43], s57 offen offset:2048 nt lds
    buffer_load_dwordx4 v17, s[40:43], s57 offen offset:3072 nt lds
    s_waitcnt lgkmcnt(0)
    s_waitcnt vmcnt(4)
    s_barrier
    s_add_u32 m0, s65, 131072
    s_xor_b32 s57, s66, 81920
    buffer_load_dwordx4 v18, s[44:47], s57 offen offset:0 nt lds
    buffer_load_dwordx4 v19, s[44:47], s57 offen offset:1024 nt lds
    buffer_load_dwordx4 v18, s[44:47], s57 offen offset:2048 nt lds
    buffer_load_dwordx4 v19, s[44:47], s57 offen offset:3072 nt lds
    s_waitcnt vmcnt(4)
    s_barrier
    s_add_u32 m0, s65, 135168
    s_xor_b32 s57, s66, 86016
    buffer_load_dwordx4 v18, s[44:47], s57 offen offset:0 nt lds
    buffer_load_dwordx4 v19, s[44:47], s57 offen offset:1024 nt lds
    buffer_load_dwordx4 v18, s[44:47], s57 offen offset:2048 nt lds
    buffer_load_dwordx4 v19, s[44:47], s57 offen offset:3072 nt lds
    s_waitcnt vmcnt(63)
    ds_write_b128 v20, v[128:131] offset:0
    ds_write_b128 v20, v[132:135] offset:1024
    ds_write_b128 v20, v[136:139] offset:2048
    ds_write_b128 v20, v[140:143] offset:3072
    s_add_u32 m0, s65, 4096
    s_xor_b32 s57, s66, 102400
    buffer_load_dwordx4 v14, s[40:43], s57 offen offset:0 nt lds
    buffer_load_dwordx4 v15, s[40:43], s57 offen offset:1024 nt lds
    buffer_load_dwordx4 v16, s[40:43], s57 offen offset:2048 nt lds
    buffer_load_dwordx4 v17, s[40:43], s57 offen offset:3072 nt lds
    s_waitcnt lgkmcnt(0)
    s_waitcnt vmcnt(20)
L_cnt0:
    v_and_b32 v24, 0xf8, v25
    v_cmp_eq_u32 vcc, 0, v24
    s_nop 4
    s_cbranch_vccz L_cnt_done0
    buffer_load_dword v25, v27, s[72:75], s71 offen sc1
    s_waitcnt vmcnt(0)
    s_sub_u32 s79, s79, 1
    s_cbranch_scc0 L_cnt0
    s_mov_b32 s79, 0
L_cnt_done0:
    s_waitcnt vmcnt(4)
    s_barrier
    s_add_u32 m0, s65, 32768
    s_xor_b32 s57, s66, 98304
    buffer_load_dwordx4 v18, s[44:47], s57 offen offset:0 nt lds
    buffer_load_dwordx4 v19, s[44:47], s57 offen offset:1024 nt lds
    buffer_load_dwordx4 v18, s[44:47], s57 offen offset:2048 nt lds
    buffer_load_dwordx4 v19, s[44:47], s57 offen offset:3072 nt lds
    s_waitcnt vmcnt(4)
    s_barrier
    s_add_u32 m0, s65, 36864
    s_xor_b32 s57, s66, 102400
    buffer_load_dwordx4 v18, s[44:47], s57 offen offset:0 nt lds
    buffer_load_dwordx4 v19, s[44:47], s57 offen offset:1024 nt lds
    buffer_load_dwordx4 v18, s[44:47], s57 offen offset:2048 nt lds
    buffer_load_dwordx4 v19, s[44:47], s57 offen offset:3072 nt lds
    s_waitcnt vmcnt(63)
    ds_write_b128 v26, v[144:147] offset:0
    ds_write_b128 v26, v[148:151] offset:1024
    ds_write_b128 v26, v[152:155] offset:2048
    ds_write_b128 v26, v[156:159] offset:3072
    ds_write_b128 v26, v[160:163] offset:4096
    ds_write_b128 v26, v[164:167] offset:5120
    ds_write_b128 v26, v[168:171] offset:6144
    ds_write_b128 v26, v[172:175] offset:7168
    s_add_u32 m0, s65, 98304
    s_xor_b32 s57, s66, 114688
    buffer_load_dwordx4 v18, s[44:47], s57 offen offset:0 nt lds
    buffer_load_dwordx4 v19, s[44:47], s57 offen offset:1024 nt lds
    buffer_load_dwordx4 v18, s[44:47], s57 offen offset:2048 nt lds
    buffer_load_dwordx4 v19, s[44:47], s57 offen offset:3072 nt lds
    s_waitcnt lgkmcnt(0)
    s_waitcnt vmcnt(4)
    s_barrier
    s_lshl_b32 s62, s55, 1
    s_add_u32 s62, s62, 0
    s_and_b32 s57, s62, 8
    s_mul_i32 s57, s57, 3
    s_add_u32 s57, s57, s62
    s_mul_i32 s57, s57, 131072
    s_add_u32 m0, s76, 131072
    s_add_u32 s57, s57, s63
    buffer_load_dwordx4 v4, s[36:39], s57 offen offset:0 lds
    buffer_load_dwordx4 v5, s[36:39], s57 offen offset:1024 lds
    buffer_load_dwordx4 v6, s[36:39], s57 offen offset:2048 lds
    buffer_load_dwordx4 v7, s[36:39], s57 offen offset:3072 lds
    s_barrier
    s_add_u32 m0, s65, 102400
    s_xor_b32 s57, s66, 118784
    buffer_load_dwordx4 v18, s[44:47], s57 offen offset:0 nt lds
    buffer_load_dwordx4 v19, s[44:47], s57 offen offset:1024 nt lds
    buffer_load_dwordx4 v18, s[44:47], s57 offen offset:2048 nt lds
    buffer_load_dwordx4 v19, s[44:47], s57 offen offset:3072 nt lds
    s_lshl_b32 s62, s55, 1
    s_add_u32 s62, s62, 1
    s_and_b32 s57, s62, 8
    s_mul_i32 s57, s57, 3
    s_add_u32 s57, s57, s62
    s_mul_i32 s57, s57, 131072
    s_add_u32 m0, s76, 147456
    s_add_u32 s57, s57, s63
    buffer_load_dwordx4 v4, s[36:39], s57 offen offset:0 lds
    buffer_load_dwordx4 v5, s[36:39], s57 offen offset:1024 lds
    buffer_load_dwordx4 v6, s[36:39], s57 offen offset:2048 lds
    buffer_load_dwordx4 v7, s[36:39], s57 offen offset:3072 lds
    s_waitcnt vmcnt(4)
L_attdone:
    s_barrier
    v_mov_b32 v24, 81936
    s_mov_b64 exec, 1
    ds_write_b32 v24, v25
    s_mov_b64 exec, -1
    s_waitcnt lgkmcnt(0)
    s_cmp_eq_u32 s55, 0
    s_cselect_b32 s66, 85419058, s66
    s_cmp_eq_u32 s55, 1
    s_cselect_b32 s66, 84370482, s66
    s_cmp_eq_u32 s55, 2
    s_cselect_b32 s66, 22050371, s66
    s_cmp_eq_u32 s55, 3
    s_cselect_b32 s66, 22153060, s66
    s_cmp_eq_u32 s55, 4
    s_cselect_b32 s66, 22225014, s66
    s_cmp_eq_u32 s55, 5
    s_cselect_b32 s66, 21176438, s66
    s_cmp_eq_u32 s55, 6
    s_cselect_b32 s66, 85209607, s66
    s_cmp_eq_u32 s55, 7
    s_cselect_b32 s66, 85345056, s66
    s_mul_i32 s71, s55, 0x1111111
    s_add_u32 s71, s71, 0x7536142
    s_cmp_eq_u32 s56, 0
    s_cselect_b32 s30, 2253664784, s30
    s_cselect_b32 s31, 15584169, s31
    s_cmp_eq_u32 s56, 1
    s_cselect_b32 s30, 2253664784, s30
    s_cselect_b32 s31, 15584169, s31
    s_cmp_eq_u32 s56, 2
    s_cselect_b32 s30, 2253664784, s30
    s_cselect_b32 s31, 15584169, s31
    s_cmp_eq_u32 s56, 3
    s_cselect_b32 s30, 2253664784, s30
    s_cselect_b32 s31, 15584169, s31
    v_bfe_u32 v22, v1, 3, 1
    s_mov_b32 s70, 0
    s_bfe_u32 s57, s30, 196608
    s_lshl_b32 s57, s57, 2
    s_bfe_u32 s58, s30, 65539
    s_cselect_b32 s62, s71, s66
    s_lshr_b32 s57, s62, s57
    s_and_b32 s57, s57, 7
    s_lshl1_add_u32 s62, s57, s58
    s_lshl3_add_u32 s60, s58, s57
    s_and_b32 s57, s62, 8
    s_mul_i32 s57, s57, 3
    s_add_u32 s57, s57, s62
    s_mul_i32 s57, s57, 131072
    s_add_u32 m0, s76, 0
    s_add_u32 s57, s57, s63
    buffer_load_dwordx4 v4, s[36:39], s57 offen offset:0 lds
    buffer_load_dwordx4 v5, s[36:39], s57 offen offset:1024 lds
    buffer_load_dwordx4 v6, s[36:39], s57 offen offset:2048 lds
    buffer_load_dwordx4 v7, s[36:39], s57 offen offset:3072 lds
    s_waitcnt vmcnt(4)
    s_barrier
L_p0:
    s_bitcmp1_b32 s70, s60
    s_cbranch_scc1 L_pd0
    s_mov_b64 exec, 0xffff
    buffer_load_dword v24, v21, s[48:51], s78 offen sc1
    s_waitcnt vmcnt(0)
    v_cmp_lt_u32 vcc, v22, v24
    s_mov_b64 exec, -1
    s_nop 2
    s_mov_b32 s70, vcc_lo
    s_sub_u32 s79, s79, 1
    s_cbranch_scc0 L_p0
    s_mov_b32 s79, 0
L_pd0:
    s_mul_i32 s58, s62, 6144
    s_add_u32 m0, s77, 0
    s_add_u32 s58, s58, s64
    buffer_load_dwordx4 v8, s[48:51], s58 offen offset:0 sc1 lds
    buffer_load_dwordx4 v9, s[48:51], s58 offen offset:1024 sc1 lds
    buffer_load_dwordx4 v10, s[48:51], s58 offen offset:2048 sc1 lds
    buffer_load_dwordx4 v11, s[48:51], s58 offen offset:3072 sc1 lds
    s_add_u32 m0, s77, 4096
    s_nop 0
    buffer_load_dwordx4 v12, s[48:51], s58 offen offset:0 sc1 lds
    buffer_load_dwordx4 v13, s[48:51], s58 offen offset:1024 sc1 lds
    s_waitcnt vmcnt(0)
    s_barrier
    s_mov_b64 exec, 0xffff
    buffer_load_dword v23, v21, s[48:51], s78 offen sc1
    s_mov_b64 exec, -1
    s_bfe_u32 s57, s30, 196612
    s_lshl_b32 s57, s57, 2
    s_bfe_u32 s58, s30, 65543
    s_cselect_b32 s62, s71, s66
    s_lshr_b32 s57, s62, s57
    s_and_b32 s57, s57, 7
    s_lshl1_add_u32 s62, s57, s58
    s_lshl3_add_u32 s60, s58, s57
L_p1:
    s_bitcmp1_b32 s70, s60
    s_cbranch_scc1 L_pd1
    s_mov_b64 exec, 0xffff
    buffer_load_dword v24, v21, s[48:51], s78 offen sc1
    s_waitcnt vmcnt(0)
    v_cmp_lt_u32 vcc, v22, v24
    s_mov_b64 exec, -1
    s_nop 2
    s_mov_b32 s70, vcc_lo
    s_sub_u32 s79, s79, 1
    s_cbranch_scc0 L_p1
    s_mov_b32 s79, 0
L_pd1:
    s_mul_i32 s58, s62, 6144
    s_add_u32 m0, s77, 40960
    s_add_u32 s58, s58, s64
    buffer_load_dwordx4 v8, s[48:51], s58 offen offset:0 sc1 lds
    buffer_load_dwordx4 v9, s[48:51], s58 offen offset:1024 sc1 lds
    buffer_load_dwordx4 v10, s[48:51], s58 offen offset:2048 sc1 lds
    buffer_load_dwordx4 v11, s[48:51], s58 offen offset:3072 sc1 lds
    s_add_u32 m0, s77, 45056
    s_nop 0
    buffer_load_dwordx4 v12, s[48:51], s58 offen offset:0 sc1 lds
    buffer_load_dwordx4 v13, s[48:51], s58 offen offset:1024 sc1 lds
    s_and_b32 s57, s62, 8
    s_mul_i32 s57, s57, 3
    s_add_u32 s57, s57, s62
    s_mul_i32 s57, s57, 131072
    s_add_u32 m0, s76, 40960
    s_add_u32 s57, s57, s63
    buffer_load_dwordx4 v4, s[36:39], s57 offen offset:0 lds
    buffer_load_dwordx4 v5, s[36:39], s57 offen offset:1024 lds
    buffer_load_dwordx4 v6, s[36:39], s57 offen offset:2048 lds
    buffer_load_dwordx4 v7, s[36:39], s57 offen offset:3072 lds
    s_bfe_u32 s57, s30, 196616
    s_lshl_b32 s57, s57, 2
    s_bfe_u32 s58, s30, 65547
    s_cselect_b32 s62, s71, s66
    s_lshr_b32 s57, s62, s57
    s_and_b32 s57, s57, 7
    s_lshl1_add_u32 s62, s57, s58
    s_lshl3_add_u32 s60, s58, s57
L_p2:
    s_bitcmp1_b32 s70, s60
    s_cbranch_scc1 L_pd2
    s_mov_b64 exec, 0xffff
    buffer_load_dword v24, v21, s[48:51], s78 offen sc1
    s_waitcnt vmcnt(0)
    v_cmp_lt_u32 vcc, v22, v24
    s_mov_b64 exec, -1
    s_nop 2
    s_mov_b32 s70, vcc_lo
    s_sub_u32 s79, s79, 1
    s_cbranch_scc0 L_p2
    s_mov_b32 s79, 0
L_pd2:
    s_mul_i32 s58, s62, 6144
    s_add_u32 m0, s77, 81920
    s_add_u32 s58, s58, s64
    buffer_load_dwordx4 v8, s[48:51], s58 offen offset:0 sc1 lds
    buffer_load_dwordx4 v9, s[48:51], s58 offen offset:1024 sc1 lds
    buffer_load_dwordx4 v10, s[48:51], s58 offen offset:2048 sc1 lds
    buffer_load_dwordx4 v11, s[48:51], s58 offen offset:3072 sc1 lds
    s_add_u32 m0, s77, 86016
    s_nop 0
    buffer_load_dwordx4 v12, s[48:51], s58 offen offset:0 sc1 lds
    buffer_load_dwordx4 v13, s[48:51], s58 offen offset:1024 sc1 lds
    s_and_b32 s57, s62, 8
    s_mul_i32 s57, s57, 3
    s_add_u32 s57, s57, s62
    s_mul_i32 s57, s57, 131072
    s_add_u32 m0, s76, 81920
    s_add_u32 s57, s57, s63
    buffer_load_dwordx4 v4, s[36:39], s57 offen offset:0 lds
    buffer_load_dwordx4 v5, s[36:39], s57 offen offset:1024 lds
    buffer_load_dwordx4 v6, s[36:39], s57 offen offset:2048 lds
    buffer_load_dwordx4 v7, s[36:39], s57 offen offset:3072 lds
    s_waitcnt vmcnt(10)
    s_barrier
    v_cmp_lt_u32 vcc, v22, v23
    s_nop 4
    s_or_b32 s70, s70, vcc_lo
    s_mov_b64 exec, 0xffff
    buffer_load_dword v23, v21, s[48:51], s78 offen sc1
    s_mov_b64 exec, -1
    s_bfe_u32 s57, s30, 196620
    s_lshl_b32 s57, s57, 2
    s_bfe_u32 s58, s30, 65551
    s_cselect_b32 s62, s71, s66
    s_lshr_b32 s57, s62, s57
    s_and_b32 s57, s57, 7
    s_lshl1_add_u32 s62, s57, s58
    s_lshl3_add_u32 s60, s58, s57
L_p3:
    s_bitcmp1_b32 s70, s60
    s_cbranch_scc1 L_pd3
    s_mov_b64 exec, 0xffff
    buffer_load_dword v24, v21, s[48:51], s78 offen sc1
    s_waitcnt vmcnt(0)
    v_cmp_lt_u32 vcc, v22, v24
    s_mov_b64 exec, -1
    s_nop 2
    s_mov_b32 s70, vcc_lo
    s_sub_u32 s79, s79, 1
    s_cbranch_scc0 L_p3
    s_mov_b32 s79, 0
L_pd3:
    s_mul_i32 s58, s62, 6144
    s_add_u32 m0, s77, 122880
    s_add_u32 s58, s58, s64
    buffer_load_dwordx4 v8, s[48:51], s58 offen offset:0 sc1 lds
    buffer_load_dwordx4 v9, s[48:51], s58 offen offset:1024 sc1 lds
    buffer_load_dwordx4 v10, s[48:51], s58 offen offset:2048 sc1 lds
    buffer_load_dwordx4 v11, s[48:51], s58 offen offset:3072 sc1 lds
    s_add_u32 m0, s77, 126976
    s_nop 0
    buffer_load_dwordx4 v12, s[48:51], s58 offen offset:0 sc1 lds
    buffer_load_dwordx4 v13, s[48:51], s58 offen offset:1024 sc1 lds
    s_and_b32 s57, s62, 8
    s_mul_i32 s57, s57, 3
    s_add_u32 s57, s57, s62
    s_mul_i32 s57, s57, 131072
    s_add_u32 m0, s76, 122880
    s_add_u32 s57, s57, s63
    buffer_load_dwordx4 v4, s[36:39], s57 offen offset:0 lds
    buffer_load_dwordx4 v5, s[36:39], s57 offen offset:1024 lds
    buffer_load_dwordx4 v6, s[36:39], s57 offen offset:2048 lds
    buffer_load_dwordx4 v7, s[36:39], s57 offen offset:3072 lds
    s_waitcnt vmcnt(10)
    s_barrier
    v_cmp_lt_u32 vcc, v22, v23
    s_nop 4
    s_or_b32 s70, s70, vcc_lo
    s_mov_b64 exec, 0xffff
    buffer_load_dword v23, v21, s[48:51], s78 offen sc1
    s_mov_b64 exec, -1
    s_bfe_u32 s57, s30, 196624
    s_lshl_b32 s57, s57, 2
    s_bfe_u32 s58, s30, 65555
    s_cselect_b32 s62, s71, s66
    s_lshr_b32 s57, s62, s57
    s_and_b32 s57, s57, 7
    s_lshl1_add_u32 s62, s57, s58
    s_lshl3_add_u32 s60, s58, s57
L_p4:
    s_bitcmp1_b32 s70, s60
    s_cbranch_scc1 L_pd4
    s_mov_b64 exec, 0xffff
    buffer_load_dword v24, v21, s[48:51], s78 offen sc1
    s_waitcnt vmcnt(0)
    v_cmp_lt_u32 vcc, v22, v24
    s_mov_b64 exec, -1
    s_nop 2
    s_mov_b32 s70, vcc_lo
    s_sub_u32 s79, s79, 1
    s_cbranch_scc0 L_p4
    s_mov_b32 s79, 0
L_pd4:
    s_mul_i32 s58, s62, 6144
    s_add_u32 m0, s77, 0
    s_add_u32 s58, s58, s64
    buffer_load_dwordx4 v8, s[48:51], s58 offen offset:0 sc1 lds
    buffer_load_dwordx4 v9, s[48:51], s58 offen offset:1024 sc1 lds
    buffer_load_dwordx4 v10, s[48:51], s58 offen offset:2048 sc1 lds
    buffer_load_dwordx4 v11, s[48:51], s58 offen offset:3072 sc1 lds
    s_add_u32 m0, s77, 4096
    s_nop 0
    buffer_load_dwordx4 v12, s[48:51], s58 offen offset:0 sc1 lds
    buffer_load_dwordx4 v13, s[48:51], s58 offen offset:1024 sc1 lds
    s_and_b32 s57, s62, 8
    s_mul_i32 s57, s57, 3
    s_add_u32 s57, s57, s62
    s_mul_i32 s57, s57, 131072
    s_add_u32 m0, s76, 0
    s_add_u32 s57, s57, s63
    buffer_load_dwordx4 v4, s[36:39], s57 offen offset:0 lds
    buffer_load_dwordx4 v5, s[36:39], s57 offen offset:1024 lds
    buffer_load_dwordx4 v6, s[36:39], s57 offen offset:2048 lds
    buffer_load_dwordx4 v7, s[36:39], s57 offen offset:3072 lds
    s_waitcnt vmcnt(10)
    s_barrier
    v_cmp_lt_u32 vcc, v22, v23
    s_nop 4
    s_or_b32 s70, s70, vcc_lo
    s_mov_b64 exec, 0xffff
    buffer_load_dword v23, v21, s[48:51], s78 offen sc1
    s_mov_b64 exec, -1
    s_bfe_u32 s57, s30, 196628
    s_lshl_b32 s57, s57, 2
    s_bfe_u32 s58, s30, 65559
    s_cselect_b32 s62, s71, s66
    s_lshr_b32 s57, s62, s57
    s_and_b32 s57, s57, 7
    s_lshl1_add_u32 s62, s57, s58
    s_lshl3_add_u32 s60, s58, s57
    s_and_b32 s57, s62, 8
    s_mul_i32 s57, s57, 3
    s_add_u32 s57, s57, s62
    s_mul_i32 s57, s57, 131072
    s_add_u32 m0, s76, 40960
    s_add_u32 s57, s57, s63
    buffer_load_dwordx4 v4, s[36:39], s57 offen offset:0 lds
    buffer_load_dwordx4 v5, s[36:39], s57 offen offset:1024 lds
    buffer_load_dwordx4 v6, s[36:39], s57 offen offset:2048 lds
    buffer_load_dwordx4 v7, s[36:39], s57 offen offset:3072 lds
L_p5:
    s_bitcmp1_b32 s70, s60
    s_cbranch_scc1 L_pd5
    s_mov_b64 exec, 0xffff
    buffer_load_dword v24, v21, s[48:51], s78 offen sc1
    s_waitcnt vmcnt(0)
    v_cmp_lt_u32 vcc, v22, v24
    s_mov_b64 exec, -1
    s_nop 2
    s_mov_b32 s70, vcc_lo
    s_sub_u32 s79, s79, 1
    s_cbranch_scc0 L_p5
    s_mov_b32 s79, 0
L_pd5:
    s_mul_i32 s58, s62, 6144
    s_add_u32 m0, s77, 40960
    s_add_u32 s58, s58, s64
    buffer_load_dwordx4 v8, s[48:51], s58 offen offset:0 sc1 lds
    buffer_load_dwordx4 v9, s[48:51], s58 offen offset:1024 sc1 lds
    buffer_load_dwordx4 v10, s[48:51], s58 offen offset:2048 sc1 lds
    buffer_load_dwordx4 v11, s[48:51], s58 offen offset:3072 sc1 lds
    s_add_u32 m0, s77, 45056
    s_nop 0
    buffer_load_dwordx4 v12, s[48:51], s58 offen offset:0 sc1 lds
    buffer_load_dwordx4 v13, s[48:51], s58 offen offset:1024 sc1 lds
    s_waitcnt vmcnt(10)
    s_barrier
    v_cmp_lt_u32 vcc, v22, v23
    s_nop 4
    s_or_b32 s70, s70, vcc_lo
    s_mov_b64 exec, 0xffff
    buffer_load_dword v23, v21, s[48:51], s78 offen sc1
    s_mov_b64 exec, -1
    s_bfe_u32 s57, s30, 196632
    s_lshl_b32 s57, s57, 2
    s_bfe_u32 s58, s30, 65563
    s_cselect_b32 s62, s71, s66
    s_lshr_b32 s57, s62, s57
    s_and_b32 s57, s57, 7
    s_lshl1_add_u32 s62, s57, s58
    s_lshl3_add_u32 s60, s58, s57
L_p6:
    s_bitcmp1_b32 s70, s60
    s_cbranch_scc1 L_pd6
    s_mov_b64 exec, 0xffff
    buffer_load_dword v24, v21, s[48:51], s78 offen sc1
    s_waitcnt vmcnt(0)
    v_cmp_lt_u32 vcc, v22, v24
    s_mov_b64 exec, -1
    s_nop 2
    s_mov_b32 s70, vcc_lo
    s_sub_u32 s79, s79, 1
    s_cbranch_scc0 L_p6
    s_mov_b32 s79, 0
L_pd6:
    s_mul_i32 s58, s62, 6144
    s_add_u32 m0, s77, 81920
    s_add_u32 s58, s58, s64
    buffer_load_dwordx4 v8, s[48:51], s58 offen offset:0 sc1 lds
    buffer_load_dwordx4 v9, s[48:51], s58 offen offset:1024 sc1 lds
    buffer_load_dwordx4 v10, s[48:51], s58 offen offset:2048 sc1 lds
    buffer_load_dwordx4 v11, s[48:51], s58 offen offset:3072 sc1 lds
    s_add_u32 m0, s77, 86016
    s_nop 0
    buffer_load_dwordx4 v12, s[48:51], s58 offen offset:0 sc1 lds
    buffer_load_dwordx4 v13, s[48:51], s58 offen offset:1024 sc1 lds
    s_and_b32 s57, s62, 8
    s_mul_i32 s57, s57, 3
    s_add_u32 s57, s57, s62
    s_mul_i32 s57, s57, 131072
    s_add_u32 m0, s76, 81920
    s_add_u32 s57, s57, s63
    buffer_load_dwordx4 v4, s[36:39], s57 offen offset:0 lds
    buffer_load_dwordx4 v5, s[36:39], s57 offen offset:1024 lds
    buffer_load_dwordx4 v6, s[36:39], s57 offen offset:2048 lds
    buffer_load_dwordx4 v7, s[36:39], s57 offen offset:3072 lds
    s_waitcnt vmcnt(10)
    s_barrier
    v_cmp_lt_u32 vcc, v22, v23
    s_nop 4
    s_or_b32 s70, s70, vcc_lo
    s_mov_b64 exec, 0xffff
    buffer_load_dword v23, v21, s[48:51], s78 offen sc1
    s_mov_b64 exec, -1
    s_bfe_u32 s57, s30, 196636
    s_lshl_b32 s57, s57, 2
    s_bfe_u32 s58, s30, 65567
    s_cselect_b32 s62, s71, s66
    s_lshr_b32 s57, s62, s57
    s_and_b32 s57, s57, 7
    s_lshl1_add_u32 s62, s57, s58
    s_lshl3_add_u32 s60, s58, s57
    s_and_b32 s57, s62, 8
    s_mul_i32 s57, s57, 3
    s_add_u32 s57, s57, s62
    s_mul_i32 s57, s57, 131072
    s_add_u32 m0, s76, 122880
    s_add_u32 s57, s57, s63
    buffer_load_dwordx4 v4, s[36:39], s57 offen offset:0 lds
    buffer_load_dwordx4 v5, s[36:39], s57 offen offset:1024 lds
    buffer_load_dwordx4 v6, s[36:39], s57 offen offset:2048 lds
    buffer_load_dwordx4 v7, s[36:39], s57 offen offset:3072 lds
L_p7:
    s_bitcmp1_b32 s70, s60
    s_cbranch_scc1 L_pd7
    s_mov_b64 exec, 0xffff
    buffer_load_dword v24, v21, s[48:51], s78 offen sc1
    s_waitcnt vmcnt(0)
    v_cmp_lt_u32 vcc, v22, v24
    s_mov_b64 exec, -1
    s_nop 2
    s_mov_b32 s70, vcc_lo
    s_sub_u32 s79, s79, 1
    s_cbranch_scc0 L_p7
    s_mov_b32 s79, 0
L_pd7:
    s_mul_i32 s58, s62, 6144
    s_add_u32 m0, s77, 122880
    s_add_u32 s58, s58, s64
    buffer_load_dwordx4 v8, s[48:51], s58 offen offset:0 sc1 lds
    buffer_load_dwordx4 v9, s[48:51], s58 offen offset:1024 sc1 lds
    buffer_load_dwordx4 v10, s[48:51], s58 offen offset:2048 sc1 lds
    buffer_load_dwordx4 v11, s[48:51], s58 offen offset:3072 sc1 lds
    s_add_u32 m0, s77, 126976
    s_nop 0
    buffer_load_dwordx4 v12, s[48:51], s58 offen offset:0 sc1 lds
    buffer_load_dwordx4 v13, s[48:51], s58 offen offset:1024 sc1 lds
    s_waitcnt vmcnt(10)
    s_barrier
    v_cmp_lt_u32 vcc, v22, v23
    s_nop 4
    s_or_b32 s70, s70, vcc_lo
    s_bfe_u32 s57, s31, 196608
    s_lshl_b32 s57, s57, 2
    s_bfe_u32 s58, s31, 65539
    s_cselect_b32 s62, s71, s66
    s_lshr_b32 s57, s62, s57
    s_and_b32 s57, s57, 7
    s_lshl1_add_u32 s62, s57, s58
    s_lshl3_add_u32 s60, s58, s57
    s_and_b32 s57, s62, 8
    s_mul_i32 s57, s57, 3
    s_add_u32 s57, s57, s62
    s_mul_i32 s57, s57, 131072
    s_add_u32 m0, s76, 0
    s_add_u32 s57, s57, s63
    buffer_load_dwordx4 v4, s[36:39], s57 offen offset:0 lds
    buffer_load_dwordx4 v5, s[36:39], s57 offen offset:1024 lds
    buffer_load_dwordx4 v6, s[36:39], s57 offen offset:2048 lds
    buffer_load_dwordx4 v7, s[36:39], s57 offen offset:3072 lds
L_p8:
    s_bitcmp1_b32 s70, s60
    s_cbranch_scc1 L_pd8
    s_mov_b64 exec, 0xffff
    buffer_load_dword v24, v21, s[48:51], s78 offen sc1
    s_waitcnt vmcnt(0)
    v_cmp_lt_u32 vcc, v22, v24
    s_mov_b64 exec, -1
    s_nop 2
    s_mov_b32 s70, vcc_lo
    s_sub_u32 s79, s79, 1
    s_cbranch_scc0 L_p8
    s_mov_b32 s79, 0
L_pd8:
    s_mul_i32 s58, s62, 6144
    s_add_u32 m0, s77, 0
    s_add_u32 s58, s58, s64
    buffer_load_dwordx4 v8, s[48:51], s58 offen offset:0 sc1 lds
    buffer_load_dwordx4 v9, s[48:51], s58 offen offset:1024 sc1 lds
    buffer_load_dwordx4 v10, s[48:51], s58 offen offset:2048 sc1 lds
    buffer_load_dwordx4 v11, s[48:51], s58 offen offset:3072 sc1 lds
    s_add_u32 m0, s77, 4096
    s_nop 0
    buffer_load_dwordx4 v12, s[48:51], s58 offen offset:0 sc1 lds
    buffer_load_dwordx4 v13, s[48:51], s58 offen offset:1024 sc1 lds
    s_waitcnt vmcnt(10)
    s_barrier
    s_bfe_u32 s57, s31, 196612
    s_lshl_b32 s57, s57, 2
    s_bfe_u32 s58, s31, 65543
    s_cselect_b32 s62, s71, s66
    s_lshr_b32 s57, s62, s57
    s_and_b32 s57, s57, 7
    s_lshl1_add_u32 s62, s57, s58
    s_lshl3_add_u32 s60, s58, s57
L_p9:
    s_bitcmp1_b32 s70, s60
    s_cbranch_scc1 L_pd9
    s_mov_b64 exec, 0xffff
    buffer_load_dword v24, v21, s[48:51], s78 offen sc1
    s_waitcnt vmcnt(0)
    v_cmp_lt_u32 vcc, v22, v24
    s_mov_b64 exec, -1
    s_nop 2
    s_mov_b32 s70, vcc_lo
    s_sub_u32 s79, s79, 1
    s_cbranch_scc0 L_p9
    s_mov_b32 s79, 0
L_pd9:
    s_mul_i32 s58, s62, 6144
    s_add_u32 m0, s77, 40960
    s_add_u32 s58, s58, s64
    buffer_load_dwordx4 v8, s[48:51], s58 offen offset:0 sc1 lds
    buffer_load_dwordx4 v9, s[48:51], s58 offen offset:1024 sc1 lds
    buffer_load_dwordx4 v10, s[48:51], s58 offen offset:2048 sc1 lds
    buffer_load_dwordx4 v11, s[48:51], s58 offen offset:3072 sc1 lds
    s_add_u32 m0, s77, 45056
    s_nop 0
    buffer_load_dwordx4 v12, s[48:51], s58 offen offset:0 sc1 lds
    buffer_load_dwordx4 v13, s[48:51], s58 offen offset:1024 sc1 lds
    s_and_b32 s57, s62, 8
    s_mul_i32 s57, s57, 3
    s_add_u32 s57, s57, s62
    s_mul_i32 s57, s57, 131072
    s_add_u32 m0, s76, 40960
    s_add_u32 s57, s57, s63
    buffer_load_dwordx4 v4, s[36:39], s57 offen offset:0 lds
    buffer_load_dwordx4 v5, s[36:39], s57 offen offset:1024 lds
    buffer_load_dwordx4 v6, s[36:39], s57 offen offset:2048 lds
    buffer_load_dwordx4 v7, s[36:39], s57 offen offset:3072 lds
    s_waitcnt vmcnt(10)
    s_barrier
    s_bfe_u32 s57, s31, 196616
    s_lshl_b32 s57, s57, 2
    s_bfe_u32 s58, s31, 65547
    s_cselect_b32 s62, s71, s66
    s_lshr_b32 s57, s62, s57
    s_and_b32 s57, s57, 7
    s_lshl1_add_u32 s62, s57, s58
    s_lshl3_add_u32 s60, s58, s57
L_p10:
    s_bitcmp1_b32 s70, s60
    s_cbranch_scc1 L_pd10
    s_mov_b64 exec, 0xffff
    buffer_load_dword v24, v21, s[48:51], s78 offen sc1
    s_waitcnt vmcnt(0)
    v_cmp_lt_u32 vcc, v22, v24
    s_mov_b64 exec, -1
    s_nop 2
    s_mov_b32 s70, vcc_lo
    s_sub_u32 s79, s79, 1
    s_cbranch_scc0 L_p10
    s_mov_b32 s79, 0
L_pd10:
    s_mul_i32 s58, s62, 6144
    s_add_u32 m0, s77, 81920
    s_add_u32 s58, s58, s64
    buffer_load_dwordx4 v8, s[48:51], s58 offen offset:0 sc1 lds
    buffer_load_dwordx4 v9, s[48:51], s58 offen offset:1024 sc1 lds
    buffer_load_dwordx4 v10, s[48:51], s58 offen offset:2048 sc1 lds
    buffer_load_dwordx4 v11, s[48:51], s58 offen offset:3072 sc1 lds
    s_add_u32 m0, s77, 86016
    s_nop 0
    buffer_load_dwordx4 v12, s[48:51], s58 offen offset:0 sc1 lds
    buffer_load_dwordx4 v13, s[48:51], s58 offen offset:1024 sc1 lds
    s_and_b32 s57, s62, 8
    s_mul_i32 s57, s57, 3
    s_add_u32 s57, s57, s62
    s_mul_i32 s57, s57, 131072
    s_add_u32 m0, s76, 81920
    s_add_u32 s57, s57, s63
    buffer_load_dwordx4 v4, s[36:39], s57 offen offset:0 lds
    buffer_load_dwordx4 v5, s[36:39], s57 offen offset:1024 lds
    buffer_load_dwordx4 v6, s[36:39], s57 offen offset:2048 lds
    buffer_load_dwordx4 v7, s[36:39], s57 offen offset:3072 lds
    s_waitcnt vmcnt(10)
    s_barrier
    s_bfe_u32 s57, s31, 196620
    s_lshl_b32 s57, s57, 2
    s_bfe_u32 s58, s31, 65551
    s_cselect_b32 s62, s71, s66
    s_lshr_b32 s57, s62, s57
    s_and_b32 s57, s57, 7
    s_lshl1_add_u32 s62, s57, s58
    s_lshl3_add_u32 s60, s58, s57
L_p11:
    s_bitcmp1_b32 s70, s60
    s_cbranch_scc1 L_pd11
    s_mov_b64 exec, 0xffff
    buffer_load_dword v24, v21, s[48:51], s78 offen sc1
    s_waitcnt vmcnt(0)
    v_cmp_lt_u32 vcc, v22, v24
    s_mov_b64 exec, -1
    s_nop 2
    s_mov_b32 s70, vcc_lo
    s_sub_u32 s79, s79, 1
    s_cbranch_scc0 L_p11
    s_mov_b32 s79, 0
L_pd11:
    s_mul_i32 s58, s62, 6144
    s_add_u32 m0, s77, 122880
    s_add_u32 s58, s58, s64
    buffer_load_dwordx4 v8, s[48:51], s58 offen offset:0 sc1 lds
    buffer_load_dwordx4 v9, s[48:51], s58 offen offset:1024 sc1 lds
    buffer_load_dwordx4 v10, s[48:51], s58 offen offset:2048 sc1 lds
    buffer_load_dwordx4 v11, s[48:51], s58 offen offset:3072 sc1 lds
    s_add_u32 m0, s77, 126976
    s_nop 0
    buffer_load_dwordx4 v12, s[48:51], s58 offen offset:0 sc1 lds
    buffer_load_dwordx4 v13, s[48:51], s58 offen offset:1024 sc1 lds
    s_and_b32 s57, s62, 8
    s_mul_i32 s57, s57, 3
    s_add_u32 s57, s57, s62
    s_mul_i32 s57, s57, 131072
    s_add_u32 m0, s76, 122880
    s_add_u32 s57, s57, s63
    buffer_load_dwordx4 v4, s[36:39], s57 offen offset:0 lds
    buffer_load_dwordx4 v5, s[36:39], s57 offen offset:1024 lds
    buffer_load_dwordx4 v6, s[36:39], s57 offen offset:2048 lds
    buffer_load_dwordx4 v7, s[36:39], s57 offen offset:3072 lds
    s_waitcnt vmcnt(10)
    s_barrier
    s_bfe_u32 s57, s31, 196624
    s_lshl_b32 s57, s57, 2
    s_bfe_u32 s58, s31, 65555
    s_cselect_b32 s62, s71, s66
    s_lshr_b32 s57, s62, s57
    s_and_b32 s57, s57, 7
    s_lshl1_add_u32 s62, s57, s58
    s_lshl3_add_u32 s60, s58, s57
L_p12:
    s_bitcmp1_b32 s70, s60
    s_cbranch_scc1 L_pd12
    s_mov_b64 exec, 0xffff
    buffer_load_dword v24, v21, s[48:51], s78 offen sc1
    s_waitcnt vmcnt(0)
    v_cmp_lt_u32 vcc, v22, v24
    s_mov_b64 exec, -1
    s_nop 2
    s_mov_b32 s70, vcc_lo
    s_sub_u32 s79, s79, 1
    s_cbranch_scc0 L_p12
    s_mov_b32 s79, 0
L_pd12:
    s_mul_i32 s58, s62, 6144
    s_add_u32 m0, s77, 0
    s_add_u32 s58, s58, s64
    buffer_load_dwordx4 v8, s[48:51], s58 offen offset:0 sc1 lds
    buffer_load_dwordx4 v9, s[48:51], s58 offen offset:1024 sc1 lds
    buffer_load_dwordx4 v10, s[48:51], s58 offen offset:2048 sc1 lds
    buffer_load_dwordx4 v11, s[48:51], s58 offen offset:3072 sc1 lds
    s_add_u32 m0, s77, 4096
    s_nop 0
    buffer_load_dwordx4 v12, s[48:51], s58 offen offset:0 sc1 lds
    buffer_load_dwordx4 v13, s[48:51], s58 offen offset:1024 sc1 lds
    s_and_b32 s57, s62, 8
    s_mul_i32 s57, s57, 3
    s_add_u32 s57, s57, s62
    s_mul_i32 s57, s57, 131072
    s_add_u32 m0, s76, 0
    s_add_u32 s57, s57, s63
    buffer_load_dwordx4 v4, s[36:39], s57 offen offset:0 lds
    buffer_load_dwordx4 v5, s[36:39], s57 offen offset:1024 lds
    buffer_load_dwordx4 v6, s[36:39], s57 offen offset:2048 lds
    buffer_load_dwordx4 v7, s[36:39], s57 offen offset:3072 lds
    s_waitcnt vmcnt(10)
    s_barrier
    s_bfe_u32 s57, s31, 196628
    s_lshl_b32 s57, s57, 2
    s_bfe_u32 s58, s31, 65559
    s_cselect_b32 s62, s71, s66
    s_lshr_b32 s57, s62, s57
    s_and_b32 s57, s57, 7
    s_lshl1_add_u32 s62, s57, s58
    s_lshl3_add_u32 s60, s58, s57
L_p13:
    s_bitcmp1_b32 s70, s60
    s_cbranch_scc1 L_pd13
    s_mov_b64 exec, 0xffff
    buffer_load_dword v24, v21, s[48:51], s78 offen sc1
    s_waitcnt vmcnt(0)
    v_cmp_lt_u32 vcc, v22, v24
    s_mov_b64 exec, -1
    s_nop 2
    s_mov_b32 s70, vcc_lo
    s_sub_u32 s79, s79, 1
    s_cbranch_scc0 L_p13
    s_mov_b32 s79, 0
L_pd13:
    s_mul_i32 s58, s62, 6144
    s_add_u32 m0, s77, 40960
    s_add_u32 s58, s58, s64
    buffer_load_dwordx4 v8, s[48:51], s58 offen offset:0 sc1 lds
    buffer_load_dwordx4 v9, s[48:51], s58 offen offset:1024 sc1 lds
    buffer_load_dwordx4 v10, s[48:51], s58 offen offset:2048 sc1 lds
    buffer_load_dwordx4 v11, s[48:51], s58 offen offset:3072 sc1 lds
    s_add_u32 m0, s77, 45056
    s_nop 0
    buffer_load_dwordx4 v12, s[48:51], s58 offen offset:0 sc1 lds
    buffer_load_dwordx4 v13, s[48:51], s58 offen offset:1024 sc1 lds
    s_and_b32 s57, s62, 8
    s_mul_i32 s57, s57, 3
    s_add_u32 s57, s57, s62
    s_mul_i32 s57, s57, 131072
    s_add_u32 m0, s76, 40960
    s_add_u32 s57, s57, s63
    buffer_load_dwordx4 v4, s[36:39], s57 offen offset:0 lds
    buffer_load_dwordx4 v5, s[36:39], s57 offen offset:1024 lds
    buffer_load_dwordx4 v6, s[36:39], s57 offen offset:2048 lds
    buffer_load_dwordx4 v7, s[36:39], s57 offen offset:3072 lds
    s_waitcnt vmcnt(10)
    s_barrier
    s_waitcnt vmcnt(0)
    s_barrier
L_end_k:
    s_endpgm
L_compute:
    s_lshl_b32 s67, s56, 3
    s_lshr_b32 s67, 100925952, s67
    s_and_b32 s67, s67, 0xff
    s_add_u32 s67, s67, s55
    s_and_b32 s67, s67, 7
    s_mov_b32 s79, 0x100000
    s_waitcnt lgkmcnt(0)
    s_mov_b32 s48, s28
    s_and_b32 s49, s29, 0xffff
    s_mov_b32 s50, 268435456
    s_mov_b32 s51, 0x20000
    s_mov_b32 s72, s26
    s_and_b32 s73, s27, 0xffff
    s_mov_b32 s74, 256
    s_mov_b32 s75, 0x20000
    s_cmp_lg_u32 s52, 0
    s_cbranch_scc1 L_noclear
    v_lshlrev_b32 v2, 7, v1
    v_mov_b64 v[4:5], 0
    s_lshl_b32 s57, s2, 10
    s_add_u32 s57, s57, 33554432
    s_mov_b64 exec, 0xff
    buffer_store_dwordx2 v[4:5], v2, s[48:51], s57 offen sc1
    s_mov_b64 exec, -1
L_noclear:
    v_lshrrev_b32 v244, 2, v1
    v_and_b32 v245, 7, v244
    v_lshlrev_b32 v245, 5, v245
    v_lshl_add_u32 v245, v244, 8, v245
    v_and_b32 v246, 3, v1
    v_lshl_add_u32 v245, v246, 3, v245
    v_add_u32 v4, 0, v245
    v_xor_b32 v5, 32, v4
    v_xor_b32 v6, 64, v4
    v_xor_b32 v7, 96, v4
    v_xor_b32 v8, 128, v4
    v_xor_b32 v9, 160, v4
    v_xor_b32 v10, 192, v4
    v_xor_b32 v11, 224, v4
    s_mul_i32 s57, s52, 6144
    s_add_u32 s57, s57, 16384
    v_and_b32 v244, 15, v1
    v_lshrrev_b32 v245, 1, v244
    v_lshrrev_b32 v246, 4, v1
    v_xor_b32 v245, v245, v246
    v_lshlrev_b32 v245, 4, v245
    v_lshl_add_u32 v245, v244, 7, v245
    v_add_u32 v12, s57, v245
    v_xor_b32 v13, 64, v12
    v_mov_b64 v[64:65], 0
    v_mov_b64 v[66:67], 0
    v_mov_b64 v[68:69], 0
    v_mov_b64 v[70:71], 0
    v_mov_b64 v[72:73], 0
    v_mov_b64 v[74:75], 0
    v_mov_b64 v[76:77], 0
    v_mov_b64 v[78:79], 0
    v_mov_b64 v[80:81], 0
    v_mov_b64 v[82:83], 0
    v_mov_b64 v[84:85], 0
    v_mov_b64 v[86:87], 0
    v_mov_b64 v[88:89], 0
    v_mov_b64 v[90:91], 0
    v_mov_b64 v[92:93], 0
    v_mov_b64 v[94:95], 0
    v_mov_b64 v[96:97], 0
    v_mov_b64 v[98:99], 0
    v_mov_b64 v[100:101], 0
    v_mov_b64 v[102:103], 0
    v_mov_b64 v[104:105], 0
    v_mov_b64 v[106:107], 0
    v_mov_b64 v[108:109], 0
    v_mov_b64 v[110:111], 0
    v_mov_b64 v[112:113], 0
    v_mov_b64 v[114:115], 0
    v_mov_b64 v[116:117], 0
    v_mov_b64 v[118:119], 0
    v_mov_b64 v[120:121], 0
    v_mov_b64 v[122:123], 0
    v_mov_b64 v[124:125], 0
    v_mov_b64 v[126:127], 0
    v_mov_b64 v[128:129], 0
    v_mov_b64 v[130:131], 0
    v_mov_b64 v[132:133], 0
    v_mov_b64 v[134:135], 0
    v_mov_b64 v[136:137], 0
    v_mov_b64 v[138:139], 0
    v_mov_b64 v[140:141], 0
    v_mov_b64 v[142:143], 0
    v_mov_b64 v[144:145], 0
    v_mov_b64 v[146:147], 0
    v_mov_b64 v[148:149], 0
    v_mov_b64 v[150:151], 0
    v_mov_b64 v[152:153], 0
    v_mov_b64 v[154:155], 0
    v_mov_b64 v[156:157], 0
    v_mov_b64 v[158:159], 0
    s_mov_b32 s61, 0
    s_mov_b32 s62, 16
    s_lshr_b32 s70, s2, 5
    s_and_b32 s70, s70, 7
    s_mul_i32 s70, s70, 2
    s_add_u32 s70, s70, 1
    s_cmp_eq_u32 s52, 0
    s_cselect_b32 s70, s70, 63
    s_mov_b32 s64, 67108864
    v_mov_b32 v2, 0
    v_mov_b32 v3, 0
    v_mov_b32 v22, 0
L_gemm_entry:
    s_barrier
    ds_read_b64_tr_b16 v[32:33], v4 offset:0
    ds_read_b64_tr_b16 v[34:35], v4 offset:4096
    ds_read_b128 v[208:211], v12 offset:0
    ds_read_b64_tr_b16 v[36:37], v5 offset:0
    ds_read_b64_tr_b16 v[38:39], v5 offset:4096
    ds_read_b128 v[212:215], v12 offset:2048
    ds_read_b64_tr_b16 v[40:41], v6 offset:0
    ds_read_b64_tr_b16 v[42:43], v6 offset:4096
    ds_read_b128 v[216:219], v12 offset:4096
    ds_read_b64_tr_b16 v[44:45], v7 offset:0
    ds_read_b64_tr_b16 v[46:47], v7 offset:4096
    ds_read_b64_tr_b16 v[48:49], v8 offset:0
    ds_read_b64_tr_b16 v[50:51], v8 offset:4096
    ds_read_b64_tr_b16 v[52:53], v9 offset:0
    ds_read_b64_tr_b16 v[54:55], v9 offset:4096
    s_mov_b32 s60, 0
    s_mov_b32 s58, 81920
    s_waitcnt lgkmcnt(12)
L_gemm:
    v_mfma_f32_16x16x32_bf16 v[64:67], v[32:35], v[208:211], v[64:67]
    s_waitcnt lgkmcnt(9)
    ds_read_b64_tr_b16 v[56:57], v10 offset:0
    v_mfma_f32_16x16x32_bf16 v[68:71], v[32:35], v[212:215], v[68:71]
    s_waitcnt lgkmcnt(7)
    ds_read_b64_tr_b16 v[58:59], v10 offset:4096
    v_mfma_f32_16x16x32_bf16 v[72:75], v[32:35], v[216:219], v[72:75]
    s_add_u32 s60, s60, 1
    s_and_b32 s57, s60, 3
    v_mfma_f32_16x16x32_bf16 v[76:79], v[36:39], v[208:211], v[76:79]
    ds_read_b64_tr_b16 v[60:61], v11 offset:0
    v_mfma_f32_16x16x32_bf16 v[80:83], v[36:39], v[212:215], v[80:83]
    ds_read_b64_tr_b16 v[62:63], v11 offset:4096
    v_mfma_f32_16x16x32_bf16 v[84:87], v[36:39], v[216:219], v[84:87]
    s_cselect_b32 s65, s58, 4294885376
    ds_read_b128 v[220:223], v13 offset:0
    v_mfma_f32_16x16x32_bf16 v[88:91], v[40:43], v[208:211], v[88:91]
    ds_read_b64_tr_b16 v[32:33], v4 offset:8192
    v_mfma_f32_16x16x32_bf16 v[92:95], v[40:43], v[212:215], v[92:95]
    ds_read_b64_tr_b16 v[34:35], v4 offset:12288
    v_mfma_f32_16x16x32_bf16 v[96:99], v[40:43], v[216:219], v[96:99]
    s_waitcnt lgkmcnt(11)
    ds_read_b128 v[224:227], v13 offset:2048
    v_mfma_f32_16x16x32_bf16 v[100:103], v[44:47], v[208:211], v[100:103]
    ds_read_b64_tr_b16 v[36:37], v5 offset:8192
    v_mfma_f32_16x16x32_bf16 v[104:107], v[44:47], v[212:215], v[104:107]
    ds_read_b64_tr_b16 v[38:39], v5 offset:12288
    v_mfma_f32_16x16x32_bf16 v[108:111], v[44:47], v[216:219], v[108:111]
    s_waitcnt lgkmcnt(12)
    ds_read_b128 v[228:231], v13 offset:4096
    v_mfma_f32_16x16x32_bf16 v[112:115], v[48:51], v[208:211], v[112:115]
    ds_read_b64_tr_b16 v[40:41], v6 offset:8192
    v_mfma_f32_16x16x32_bf16 v[116:119], v[48:51], v[212:215], v[116:119]
    ds_read_b64_tr_b16 v[42:43], v6 offset:12288
    v_mfma_f32_16x16x32_bf16 v[120:123], v[48:51], v[216:219], v[120:123]
    s_waitcnt lgkmcnt(13)
    v_mfma_f32_16x16x32_bf16 v[124:127], v[52:55], v[208:211], v[124:127]
    ds_read_b64_tr_b16 v[44:45], v7 offset:8192
    v_mfma_f32_16x16x32_bf16 v[128:131], v[52:55], v[212:215], v[128:131]
    ds_read_b64_tr_b16 v[46:47], v7 offset:12288
    v_mfma_f32_16x16x32_bf16 v[132:135], v[52:55], v[216:219], v[132:135]
    s_waitcnt lgkmcnt(13)
    v_mfma_f32_16x16x32_bf16 v[136:139], v[56:59], v[208:211], v[136:139]
    ds_read_b64_tr_b16 v[48:49], v8 offset:8192
    v_mfma_f32_16x16x32_bf16 v[140:143], v[56:59], v[212:215], v[140:143]
    ds_read_b64_tr_b16 v[50:51], v8 offset:12288
    v_mfma_f32_16x16x32_bf16 v[144:147], v[56:59], v[216:219], v[144:147]
    s_waitcnt lgkmcnt(13)
    v_mfma_f32_16x16x32_bf16 v[148:151], v[60:63], v[208:211], v[148:151]
    ds_read_b64_tr_b16 v[52:53], v9 offset:8192
    v_mfma_f32_16x16x32_bf16 v[152:155], v[60:63], v[212:215], v[152:155]
    ds_read_b64_tr_b16 v[54:55], v9 offset:12288
    v_mfma_f32_16x16x32_bf16 v[156:159], v[60:63], v[216:219], v[156:159]
    s_waitcnt lgkmcnt(12)
    s_cmp_eq_u32 s60, s70
    s_cbranch_scc1 L_flag1
L_flag1_ret:
    v_mfma_f32_16x16x32_bf16 v[64:67], v[32:35], v[220:223], v[64:67]
    s_waitcnt lgkmcnt(11)
    ds_read_b64_tr_b16 v[56:57], v10 offset:8192
    v_mfma_f32_16x16x32_bf16 v[68:71], v[32:35], v[224:227], v[68:71]
    s_waitcnt lgkmcnt(9)
    ds_read_b64_tr_b16 v[58:59], v10 offset:12288
    v_mfma_f32_16x16x32_bf16 v[72:75], v[32:35], v[228:231], v[72:75]
    v_mfma_f32_16x16x32_bf16 v[76:79], v[36:39], v[220:223], v[76:79]
    ds_read_b64_tr_b16 v[60:61], v11 offset:8192
    v_mfma_f32_16x16x32_bf16 v[80:83], v[36:39], v[224:227], v[80:83]
    ds_read_b64_tr_b16 v[62:63], v11 offset:12288
    v_mfma_f32_16x16x32_bf16 v[84:87], v[36:39], v[228:231], v[84:87]
    s_waitcnt lgkmcnt(10)
    s_barrier
    v_mfma_f32_16x16x32_bf16 v[88:91], v[40:43], v[220:223], v[88:91]
    ds_read_b64_tr_b16 v[32:33], v4 offset:40960
    v_mfma_f32_16x16x32_bf16 v[92:95], v[40:43], v[224:227], v[92:95]
    ds_read_b64_tr_b16 v[34:35], v4 offset:45056
    v_mfma_f32_16x16x32_bf16 v[96:99], v[40:43], v[228:231], v[96:99]
    s_waitcnt lgkmcnt(10)
    ds_read_b128 v[208:211], v12 offset:40960
    v_mfma_f32_16x16x32_bf16 v[100:103], v[44:47], v[220:223], v[100:103]
    ds_read_b64_tr_b16 v[36:37], v5 offset:40960
    v_mfma_f32_16x16x32_bf16 v[104:107], v[44:47], v[224:227], v[104:107]
    ds_read_b64_tr_b16 v[38:39], v5 offset:45056
    v_mfma_f32_16x16x32_bf16 v[108:111], v[44:47], v[228:231], v[108:111]
    s_waitcnt lgkmcnt(11)
    ds_read_b128 v[212:215], v12 offset:43008
    v_mfma_f32_16x16x32_bf16 v[112:115], v[48:51], v[220:223], v[112:115]
    ds_read_b64_tr_b16 v[40:41], v6 offset:40960
    v_mfma_f32_16x16x32_bf16 v[116:119], v[48:51], v[224:227], v[116:119]
    ds_read_b64_tr_b16 v[42:43], v6 offset:45056
    v_mfma_f32_16x16x32_bf16 v[120:123], v[48:51], v[228:231], v[120:123]
    s_waitcnt lgkmcnt(12)
    ds_read_b128 v[216:219], v12 offset:45056
    v_mfma_f32_16x16x32_bf16 v[124:127], v[52:55], v[220:223], v[124:127]
    ds_read_b64_tr_b16 v[44:45], v7 offset:40960
    v_mfma_f32_16x16x32_bf16 v[128:131], v[52:55], v[224:227], v[128:131]
    ds_read_b64_tr_b16 v[46:47], v7 offset:45056
    v_mfma_f32_16x16x32_bf16 v[132:135], v[52:55], v[228:231], v[132:135]
    s_waitcnt lgkmcnt(13)
    v_mfma_f32_16x16x32_bf16 v[136:139], v[56:59], v[220:223], v[136:139]
    ds_read_b64_tr_b16 v[48:49], v8 offset:40960
    v_mfma_f32_16x16x32_bf16 v[140:143], v[56:59], v[224:227], v[140:143]
    ds_read_b64_tr_b16 v[50:51], v8 offset:45056
    v_mfma_f32_16x16x32_bf16 v[144:147], v[56:59], v[228:231], v[144:147]
    s_waitcnt lgkmcnt(13)
    v_mfma_f32_16x16x32_bf16 v[148:151], v[60:63], v[220:223], v[148:151]
    ds_read_b64_tr_b16 v[52:53], v9 offset:40960
    v_mfma_f32_16x16x32_bf16 v[152:155], v[60:63], v[224:227], v[152:155]
    ds_read_b64_tr_b16 v[54:55], v9 offset:45056
    v_mfma_f32_16x16x32_bf16 v[156:159], v[60:63], v[228:231], v[156:159]
    s_waitcnt lgkmcnt(12)
    v_mfma_f32_16x16x32_bf16 v[64:67], v[32:35], v[208:211], v[64:67]
    s_waitcnt lgkmcnt(9)
    ds_read_b64_tr_b16 v[56:57], v10 offset:40960
    v_mfma_f32_16x16x32_bf16 v[68:71], v[32:35], v[212:215], v[68:71]
    s_waitcnt lgkmcnt(7)
    ds_read_b64_tr_b16 v[58:59], v10 offset:45056
    v_mfma_f32_16x16x32_bf16 v[72:75], v[32:35], v[216:219], v[72:75]
    s_add_u32 s60, s60, 1
    s_and_b32 s57, s60, 3
    v_mfma_f32_16x16x32_bf16 v[76:79], v[36:39], v[208:211], v[76:79]
    ds_read_b64_tr_b16 v[60:61], v11 offset:40960
    v_mfma_f32_16x16x32_bf16 v[80:83], v[36:39], v[212:215], v[80:83]
    ds_read_b64_tr_b16 v[62:63], v11 offset:45056
    v_mfma_f32_16x16x32_bf16 v[84:87], v[36:39], v[216:219], v[84:87]
    s_cselect_b32 s65, s58, 4294885376
    ds_read_b128 v[220:223], v13 offset:40960
    v_mfma_f32_16x16x32_bf16 v[88:91], v[40:43], v[208:211], v[88:91]
    ds_read_b64_tr_b16 v[32:33], v4 offset:49152
    v_mfma_f32_16x16x32_bf16 v[92:95], v[40:43], v[212:215], v[92:95]
    ds_read_b64_tr_b16 v[34:35], v4 offset:53248
    v_mfma_f32_16x16x32_bf16 v[96:99], v[40:43], v[216:219], v[96:99]
    s_waitcnt lgkmcnt(11)
    ds_read_b128 v[224:227], v13 offset:43008
    v_mfma_f32_16x16x32_bf16 v[100:103], v[44:47], v[208:211], v[100:103]
    ds_read_b64_tr_b16 v[36:37], v5 offset:49152
    v_mfma_f32_16x16x32_bf16 v[104:107], v[44:47], v[212:215], v[104:107]
    ds_read_b64_tr_b16 v[38:39], v5 offset:53248
    v_add_u32 v4, s65, v4
    v_mfma_f32_16x16x32_bf16 v[108:111], v[44:47], v[216:219], v[108:111]
    s_waitcnt lgkmcnt(12)
    ds_read_b128 v[228:231], v13 offset:45056
    v_mfma_f32_16x16x32_bf16 v[112:115], v[48:51], v[208:211], v[112:115]
    ds_read_b64_tr_b16 v[40:41], v6 offset:49152
    v_mfma_f32_16x16x32_bf16 v[116:119], v[48:51], v[212:215], v[116:119]
    ds_read_b64_tr_b16 v[42:43], v6 offset:53248
    v_add_u32 v5, s65, v5
    v_mfma_f32_16x16x32_bf16 v[120:123], v[48:51], v[216:219], v[120:123]
    s_waitcnt lgkmcnt(13)
    v_mfma_f32_16x16x32_bf16 v[124:127], v[52:55], v[208:211], v[124:127]
    ds_read_b64_tr_b16 v[44:45], v7 offset:49152
    v_mfma_f32_16x16x32_bf16 v[128:131], v[52:55], v[212:215], v[128:131]
    ds_read_b64_tr_b16 v[46:47], v7 offset:53248
    v_add_u32 v6, s65, v6
    v_mfma_f32_16x16x32_bf16 v[132:135], v[52:55], v[216:219], v[132:135]
    s_waitcnt lgkmcnt(13)
    v_add_u32 v12, s65, v12
    v_mfma_f32_16x16x32_bf16 v[136:139], v[56:59], v[208:211], v[136:139]
    ds_read_b64_tr_b16 v[48:49], v8 offset:49152
    v_mfma_f32_16x16x32_bf16 v[140:143], v[56:59], v[212:215], v[140:143]
    ds_read_b64_tr_b16 v[50:51], v8 offset:53248
    v_add_u32 v7, s65, v7
    v_mfma_f32_16x16x32_bf16 v[144:147], v[56:59], v[216:219], v[144:147]
    s_waitcnt lgkmcnt(13)
    v_add_u32 v13, s65, v13
    v_mfma_f32_16x16x32_bf16 v[148:151], v[60:63], v[208:211], v[148:151]
    ds_read_b64_tr_b16 v[52:53], v9 offset:49152
    v_mfma_f32_16x16x32_bf16 v[152:155], v[60:63], v[212:215], v[152:155]
    ds_read_b64_tr_b16 v[54:55], v9 offset:53248
    v_add_u32 v8, s65, v8
    v_mfma_f32_16x16x32_bf16 v[156:159], v[60:63], v[216:219], v[156:159]
    s_waitcnt lgkmcnt(12)
    v_mfma_f32_16x16x32_bf16 v[64:67], v[32:35], v[220:223], v[64:67]
    s_waitcnt lgkmcnt(11)
    ds_read_b64_tr_b16 v[56:57], v10 offset:49152
    v_mfma_f32_16x16x32_bf16 v[68:71], v[32:35], v[224:227], v[68:71]
    s_waitcnt lgkmcnt(9)
    ds_read_b64_tr_b16 v[58:59], v10 offset:53248
    v_add_u32 v9, s65, v9
    v_mfma_f32_16x16x32_bf16 v[72:75], v[32:35], v[228:231], v[72:75]
    v_mfma_f32_16x16x32_bf16 v[76:79], v[36:39], v[220:223], v[76:79]
    ds_read_b64_tr_b16 v[60:61], v11 offset:49152
    v_mfma_f32_16x16x32_bf16 v[80:83], v[36:39], v[224:227], v[80:83]
    ds_read_b64_tr_b16 v[62:63], v11 offset:53248
    v_add_u32 v10, s65, v10
    v_mfma_f32_16x16x32_bf16 v[84:87], v[36:39], v[228:231], v[84:87]
    s_waitcnt lgkmcnt(10)
    s_barrier
    v_mfma_f32_16x16x32_bf16 v[88:91], v[40:43], v[220:223], v[88:91]
    ds_read_b64_tr_b16 v[32:33], v4 offset:0
    v_mfma_f32_16x16x32_bf16 v[92:95], v[40:43], v[224:227], v[92:95]
    ds_read_b64_tr_b16 v[34:35], v4 offset:4096
    v_add_u32 v11, s65, v11
    v_mfma_f32_16x16x32_bf16 v[96:99], v[40:43], v[228:231], v[96:99]
    s_waitcnt lgkmcnt(10)
    ds_read_b128 v[208:211], v12 offset:0
    v_mfma_f32_16x16x32_bf16 v[100:103], v[44:47], v[220:223], v[100:103]
    ds_read_b64_tr_b16 v[36:37], v5 offset:0
    v_mfma_f32_16x16x32_bf16 v[104:107], v[44:47], v[224:227], v[104:107]
    ds_read_b64_tr_b16 v[38:39], v5 offset:4096
    v_mfma_f32_16x16x32_bf16 v[108:111], v[44:47], v[228:231], v[108:111]
    s_waitcnt lgkmcnt(11)
    ds_read_b128 v[212:215], v12 offset:2048
    v_mfma_f32_16x16x32_bf16 v[112:115], v[48:51], v[220:223], v[112:115]
    ds_read_b64_tr_b16 v[40:41], v6 offset:0
    v_mfma_f32_16x16x32_bf16 v[116:119], v[48:51], v[224:227], v[116:119]
    ds_read_b64_tr_b16 v[42:43], v6 offset:4096
    v_mfma_f32_16x16x32_bf16 v[120:123], v[48:51], v[228:231], v[120:123]
    s_waitcnt lgkmcnt(12)
    ds_read_b128 v[216:219], v12 offset:4096
    v_mfma_f32_16x16x32_bf16 v[124:127], v[52:55], v[220:223], v[124:127]
    ds_read_b64_tr_b16 v[44:45], v7 offset:0
    v_mfma_f32_16x16x32_bf16 v[128:131], v[52:55], v[224:227], v[128:131]
    ds_read_b64_tr_b16 v[46:47], v7 offset:4096
    v_mfma_f32_16x16x32_bf16 v[132:135], v[52:55], v[228:231], v[132:135]
    s_waitcnt lgkmcnt(13)
    v_mfma_f32_16x16x32_bf16 v[136:139], v[56:59], v[220:223], v[136:139]
    ds_read_b64_tr_b16 v[48:49], v8 offset:0
    v_mfma_f32_16x16x32_bf16 v[140:143], v[56:59], v[224:227], v[140:143]
    ds_read_b64_tr_b16 v[50:51], v8 offset:4096
    v_mfma_f32_16x16x32_bf16 v[144:147], v[56:59], v[228:231], v[144:147]
    s_waitcnt lgkmcnt(13)
    s_cmp_lt_u32 s60, s62
    v_mfma_f32_16x16x32_bf16 v[148:151], v[60:63], v[220:223], v[148:151]
    ds_read_b64_tr_b16 v[52:53], v9 offset:0
    v_mfma_f32_16x16x32_bf16 v[152:155], v[60:63], v[224:227], v[152:155]
    ds_read_b64_tr_b16 v[54:55], v9 offset:4096
    v_mfma_f32_16x16x32_bf16 v[156:159], v[60:63], v[228:231], v[156:159]
    s_waitcnt lgkmcnt(12)
    s_cbranch_scc1 L_gemm
    s_cmp_eq_u32 s61, 1
    s_cbranch_scc1 L_final
    s_waitcnt lgkmcnt(0)
    s_nop 7
    s_mov_b32 s68, 1040356334
    s_mov_b32 s69, 1040356334
    s_lshr_b32 s57, s52, 1
    s_lshl_b32 s57, s57, 14
    v_lshrrev_b32 v244, 4, v1
    v_and_b32 v245, 1, v244
    v_lshrrev_b32 v244, 1, v244
    v_lshl_or_b32 v244, v245, 1, v244
    v_and_b32 v245, 15, v1
    v_xor_b32 v244, v244, v245
    v_lshlrev_b32 v244, 4, v244
    v_lshl_add_u32 v244, v245, 8, v244
    v_add_u32 v12, s57, v244
    v_xor_b32 v13, 64, v12
    v_xor_b32 v14, 128, v12
    v_xor_b32 v15, 192, v12
    s_add_u32 s57, s57, 32768
    v_lshrrev_b32 v244, 2, v1
    v_and_b32 v245, 7, v244
    v_lshlrev_b32 v245, 5, v245
    v_lshl_add_u32 v245, v244, 8, v245
    v_and_b32 v246, 3, v1
    v_lshl_add_u32 v245, v246, 3, v245
    v_add_u32 v4, s57, v245
    v_xor_b32 v5, 32, v4
    v_xor_b32 v6, 64, v4
    v_xor_b32 v7, 96, v4
    v_xor_b32 v8, 128, v4
    v_xor_b32 v9, 160, v4
    v_xor_b32 v10, 192, v4
    v_xor_b32 v11, 224, v4
    s_lshl_b32 s66, s54, 6
    s_xor_b32 s66, s66, s57
    s_xor_b32 s66, s66, 196608
    s_mov_b32 s76, 65536
    s_mov_b32 s77, 229376
    s_mov_b32 s71, 163840
    v_mov_b32 v16, 0x7f800000
    v_mov_b64 v[2:3], 0
    v_mov_b32 v20, 0x7f800000
    v_mov_b64 v[28:29], 0
    v_mov_b32 v24, 0x7f800000
    v_mov_b64 v[30:31], 0
    v_pk_mul_f32 v[64:65], v[64:65], s[68:69]
    v_pk_mul_f32 v[66:67], v[66:67], s[68:69]
    v_pk_mul_f32 v[76:77], v[76:77], s[68:69]
    v_pk_mul_f32 v[78:79], v[78:79], s[68:69]
    v_cvt_pk_bf16_f32 v160, v64, v65
    v_cvt_pk_bf16_f32 v161, v66, v67
    v_cvt_pk_bf16_f32 v162, v76, v77
    v_cvt_pk_bf16_f32 v163, v78, v79
    v_pk_mul_f32 v[68:69], v[68:69], s[68:69]
    v_pk_mul_f32 v[70:71], v[70:71], s[68:69]
    v_pk_mul_f32 v[80:81], v[80:81], s[68:69]
    v_pk_mul_f32 v[82:83], v[82:83], s[68:69]
    v_cvt_pk_bf16_f32 v176, v68, v69
    v_cvt_pk_bf16_f32 v177, v70, v71
    v_cvt_pk_bf16_f32 v178, v80, v81
    v_cvt_pk_bf16_f32 v179, v82, v83
    v_pk_mul_f32 v[72:73], v[72:73], s[68:69]
    v_pk_mul_f32 v[74:75], v[74:75], s[68:69]
    v_pk_mul_f32 v[84:85], v[84:85], s[68:69]
    v_pk_mul_f32 v[86:87], v[86:87], s[68:69]
    v_cvt_pk_bf16_f32 v192, v72, v73
    v_cvt_pk_bf16_f32 v193, v74, v75
    v_cvt_pk_bf16_f32 v194, v84, v85
    v_cvt_pk_bf16_f32 v195, v86, v87
    v_pk_mul_f32 v[88:89], v[88:89], s[68:69]
    v_pk_mul_f32 v[90:91], v[90:91], s[68:69]
    v_pk_mul_f32 v[100:101], v[100:101], s[68:69]
    v_pk_mul_f32 v[102:103], v[102:103], s[68:69]
    v_cvt_pk_bf16_f32 v164, v88, v89
    v_cvt_pk_bf16_f32 v165, v90, v91
    v_cvt_pk_bf16_f32 v166, v100, v101
    v_cvt_pk_bf16_f32 v167, v102, v103
    v_pk_mul_f32 v[92:93], v[92:93], s[68:69]
    v_pk_mul_f32 v[94:95], v[94:95], s[68:69]
    v_pk_mul_f32 v[104:105], v[104:105], s[68:69]
    v_pk_mul_f32 v[106:107], v[106:107], s[68:69]
    v_cvt_pk_bf16_f32 v180, v92, v93
    v_cvt_pk_bf16_f32 v181, v94, v95
    v_cvt_pk_bf16_f32 v182, v104, v105
    v_cvt_pk_bf16_f32 v183, v106, v107
    v_pk_mul_f32 v[96:97], v[96:97], s[68:69]
    v_pk_mul_f32 v[98:99], v[98:99], s[68:69]
    v_pk_mul_f32 v[108:109], v[108:109], s[68:69]
    v_pk_mul_f32 v[110:111], v[110:111], s[68:69]
    v_cvt_pk_bf16_f32 v196, v96, v97
    v_cvt_pk_bf16_f32 v197, v98, v99
    v_cvt_pk_bf16_f32 v198, v108, v109
    v_cvt_pk_bf16_f32 v199, v110, v111
    v_pk_mul_f32 v[112:113], v[112:113], s[68:69]
    v_pk_mul_f32 v[114:115], v[114:115], s[68:69]
    v_pk_mul_f32 v[124:125], v[124:125], s[68:69]
    v_pk_mul_f32 v[126:127], v[126:127], s[68:69]
    v_cvt_pk_bf16_f32 v168, v112, v113
    v_cvt_pk_bf16_f32 v169, v114, v115
    v_cvt_pk_bf16_f32 v170, v124, v125
    v_cvt_pk_bf16_f32 v171, v126, v127
    v_pk_mul_f32 v[116:117], v[116:117], s[68:69]
    v_pk_mul_f32 v[118:119], v[118:119], s[68:69]
    v_pk_mul_f32 v[128:129], v[128:129], s[68:69]
    v_pk_mul_f32 v[130:131], v[130:131], s[68:69]
    v_cvt_pk_bf16_f32 v184, v116, v117
    v_cvt_pk_bf16_f32 v185, v118, v119
    v_cvt_pk_bf16_f32 v186, v128, v129
    v_cvt_pk_bf16_f32 v187, v130, v131
    v_pk_mul_f32 v[120:121], v[120:121], s[68:69]
    v_pk_mul_f32 v[122:123], v[122:123], s[68:69]
    v_pk_mul_f32 v[132:133], v[132:133], s[68:69]
    v_pk_mul_f32 v[134:135], v[134:135], s[68:69]
    v_cvt_pk_bf16_f32 v200, v120, v121
    v_cvt_pk_bf16_f32 v201, v122, v123
    v_cvt_pk_bf16_f32 v202, v132, v133
    v_cvt_pk_bf16_f32 v203, v134, v135
    v_pk_mul_f32 v[136:137], v[136:137], s[68:69]
    v_pk_mul_f32 v[138:139], v[138:139], s[68:69]
    v_pk_mul_f32 v[148:149], v[148:149], s[68:69]
    v_pk_mul_f32 v[150:151], v[150:151], s[68:69]
    v_cvt_pk_bf16_f32 v172, v136, v137
    v_cvt_pk_bf16_f32 v173, v138, v139
    v_cvt_pk_bf16_f32 v174, v148, v149
    v_cvt_pk_bf16_f32 v175, v150, v151
    v_pk_mul_f32 v[140:141], v[140:141], s[68:69]
    v_pk_mul_f32 v[142:143], v[142:143], s[68:69]
    v_pk_mul_f32 v[152:153], v[152:153], s[68:69]
    v_pk_mul_f32 v[154:155], v[154:155], s[68:69]
    v_cvt_pk_bf16_f32 v188, v140, v141
    v_cvt_pk_bf16_f32 v189, v142, v143
    v_cvt_pk_bf16_f32 v190, v152, v153
    v_cvt_pk_bf16_f32 v191, v154, v155
    v_pk_mul_f32 v[144:145], v[144:145], s[68:69]
    v_pk_mul_f32 v[146:147], v[146:147], s[68:69]
    v_pk_mul_f32 v[156:157], v[156:157], s[68:69]
    v_pk_mul_f32 v[158:159], v[158:159], s[68:69]
    v_cvt_pk_bf16_f32 v204, v144, v145
    v_cvt_pk_bf16_f32 v205, v146, v147
    v_cvt_pk_bf16_f32 v206, v156, v157
    v_cvt_pk_bf16_f32 v207, v158, v159
    v_permlane16_swap_b32 v160, v162
    v_permlane16_swap_b32 v161, v163
    v_permlane16_swap_b32 v164, v166
    v_permlane16_swap_b32 v165, v167
    v_permlane16_swap_b32 v168, v170
    v_permlane16_swap_b32 v169, v171
    v_permlane16_swap_b32 v172, v174
    v_permlane16_swap_b32 v173, v175
    v_permlane16_swap_b32 v176, v178
    v_permlane16_swap_b32 v177, v179
    v_permlane16_swap_b32 v180, v182
    v_permlane16_swap_b32 v181, v183
    v_permlane16_swap_b32 v184, v186
    v_permlane16_swap_b32 v185, v187
    v_permlane16_swap_b32 v188, v190
    v_permlane16_swap_b32 v189, v191
    v_permlane16_swap_b32 v192, v194
    v_permlane16_swap_b32 v193, v195
    v_permlane16_swap_b32 v196, v198
    v_permlane16_swap_b32 v197, v199
    v_permlane16_swap_b32 v200, v202
    v_permlane16_swap_b32 v201, v203
    v_permlane16_swap_b32 v204, v206
    v_permlane16_swap_b32 v205, v207
    s_mov_b32 s60, 0
    s_mov_b32 s65, 65536
    s_mov_b32 s78, 1199570944
L_exact:
    s_nop 7
    ds_read_b128 v[32:35], v12 offset:0
    ds_read_b128 v[36:39], v13 offset:0
    ds_read_b128 v[40:43], v14 offset:0
    ds_read_b128 v[44:47], v15 offset:0
    ds_read_b128 v[48:51], v12 offset:4096
    ds_read_b128 v[52:55], v13 offset:4096
    s_waitcnt lgkmcnt(5)
    v_mfma_f32_16x16x32_bf16 v[208:211], v[32:35], v[160:163], 0
    ds_read_b128 v[56:59], v14 offset:4096
    v_mfma_f32_16x16x32_bf16 v[212:215], v[32:35], v[176:179], 0
    v_mfma_f32_16x16x32_bf16 v[216:219], v[32:35], v[192:195], 0
    s_waitcnt lgkmcnt(5)
    v_mfma_f32_16x16x32_bf16 v[208:211], v[36:39], v[164:167], v[208:211]
    ds_read_b128 v[60:63], v15 offset:4096
    v_mfma_f32_16x16x32_bf16 v[212:215], v[36:39], v[180:183], v[212:215]
    v_mfma_f32_16x16x32_bf16 v[216:219], v[36:39], v[196:199], v[216:219]
    s_waitcnt lgkmcnt(5)
    v_mfma_f32_16x16x32_bf16 v[208:211], v[40:43], v[168:171], v[208:211]
    ds_read_b128 v[32:35], v12 offset:8192
    v_mfma_f32_16x16x32_bf16 v[212:215], v[40:43], v[184:187], v[212:215]
    v_mfma_f32_16x16x32_bf16 v[216:219], v[40:43], v[200:203], v[216:219]
    s_waitcnt lgkmcnt(5)
    v_mfma_f32_16x16x32_bf16 v[208:211], v[44:47], v[172:175], v[208:211]
    ds_read_b128 v[36:39], v13 offset:8192
    v_mfma_f32_16x16x32_bf16 v[212:215], v[44:47], v[188:191], v[212:215]
    v_mfma_f32_16x16x32_bf16 v[216:219], v[44:47], v[204:207], v[216:219]
    s_waitcnt lgkmcnt(5)
    v_mfma_f32_16x16x32_bf16 v[220:223], v[48:51], v[160:163], 0
    ds_read_b128 v[40:43], v14 offset:8192
    v_mfma_f32_16x16x32_bf16 v[224:227], v[48:51], v[176:179], 0
    v_mfma_f32_16x16x32_bf16 v[228:231], v[48:51], v[192:195], 0
    s_waitcnt lgkmcnt(5)
    v_mfma_f32_16x16x32_bf16 v[220:223], v[52:55], v[164:167], v[220:223]
    ds_read_b128 v[44:47], v15 offset:8192
    v_mfma_f32_16x16x32_bf16 v[224:227], v[52:55], v[180:183], v[224:227]
    v_mfma_f32_16x16x32_bf16 v[228:231], v[52:55], v[196:199], v[228:231]
    s_waitcnt lgkmcnt(5)
    v_mfma_f32_16x16x32_bf16 v[220:223], v[56:59], v[168:171], v[220:223]
    ds_read_b128 v[48:51], v12 offset:12288
    v_mfma_f32_16x16x32_bf16 v[224:227], v[56:59], v[184:187], v[224:227]
    v_mfma_f32_16x16x32_bf16 v[228:231], v[56:59], v[200:203], v[228:231]
    s_waitcnt lgkmcnt(5)
    v_mfma_f32_16x16x32_bf16 v[220:223], v[60:63], v[172:175], v[220:223]
    ds_read_b128 v[52:55], v13 offset:12288
    v_mfma_f32_16x16x32_bf16 v[224:227], v[60:63], v[188:191], v[224:227]
    v_mfma_f32_16x16x32_bf16 v[228:231], v[60:63], v[204:207], v[228:231]
    s_waitcnt lgkmcnt(5)
    v_mfma_f32_16x16x32_bf16 v[232:235], v[32:35], v[160:163], 0
    ds_read_b128 v[56:59], v14 offset:12288
    v_mfma_f32_16x16x32_bf16 v[236:239], v[32:35], v[176:179], 0
    v_mfma_f32_16x16x32_bf16 v[240:243], v[32:35], v[192:195], 0
    s_waitcnt lgkmcnt(5)
    v_mfma_f32_16x16x32_bf16 v[232:235], v[36:39], v[164:167], v[232:235]
    ds_read_b128 v[60:63], v15 offset:12288
    v_mfma_f32_16x16x32_bf16 v[236:239], v[36:39], v[180:183], v[236:239]
    v_mfma_f32_16x16x32_bf16 v[240:243], v[36:39], v[196:199], v[240:243]
    s_waitcnt lgkmcnt(5)
    v_mfma_f32_16x16x32_bf16 v[232:235], v[40:43], v[168:171], v[232:235]
    v_mfma_f32_16x16x32_bf16 v[236:239], v[40:43], v[184:187], v[236:239]
    v_mfma_f32_16x16x32_bf16 v[240:243], v[40:43], v[200:203], v[240:243]
    s_waitcnt lgkmcnt(4)
    v_mfma_f32_16x16x32_bf16 v[232:235], v[44:47], v[172:175], v[232:235]
    v_mfma_f32_16x16x32_bf16 v[236:239], v[44:47], v[188:191], v[236:239]
    v_mfma_f32_16x16x32_bf16 v[240:243], v[44:47], v[204:207], v[240:243]
    s_waitcnt lgkmcnt(3)
    v_mfma_f32_16x16x32_bf16 v[244:247], v[48:51], v[160:163], 0
    v_mfma_f32_16x16x32_bf16 v[248:251], v[48:51], v[176:179], 0
    v_mfma_f32_16x16x32_bf16 v[252:255], v[48:51], v[192:195], 0
    s_waitcnt lgkmcnt(2)
    v_mfma_f32_16x16x32_bf16 v[244:247], v[52:55], v[164:167], v[244:247]
    v_mfma_f32_16x16x32_bf16 v[248:251], v[52:55], v[180:183], v[248:251]
    v_mfma_f32_16x16x32_bf16 v[252:255], v[52:55], v[196:199], v[252:255]
    s_waitcnt lgkmcnt(1)
    v_mfma_f32_16x16x32_bf16 v[244:247], v[56:59], v[168:171], v[244:247]
    v_mfma_f32_16x16x32_bf16 v[248:251], v[56:59], v[184:187], v[248:251]
    v_mfma_f32_16x16x32_bf16 v[252:255], v[56:59], v[200:203], v[252:255]
    s_waitcnt lgkmcnt(0)
    v_mfma_f32_16x16x32_bf16 v[244:247], v[60:63], v[172:175], v[244:247]
    v_mfma_f32_16x16x32_bf16 v[248:251], v[60:63], v[188:191], v[248:251]
    v_mfma_f32_16x16x32_bf16 v[252:255], v[60:63], v[204:207], v[252:255]
    v_max3_f32 v40, -v16, v208, v209
    v_max3_f32 v42, -v20, v212, v213
    v_max3_f32 v44, -v24, v216, v217
    v_max3_f32 v40, v40, v210, v211
    v_max3_f32 v42, v42, v214, v215
    v_max3_f32 v44, v44, v218, v219
    v_max3_f32 v40, v40, v220, v221
    v_max3_f32 v42, v42, v224, v225
    v_max3_f32 v44, v44, v228, v229
    v_max3_f32 v40, v40, v222, v223
    v_max3_f32 v42, v42, v226, v227
    v_max3_f32 v44, v44, v230, v231
    v_max3_f32 v40, v40, v232, v233
    v_max3_f32 v42, v42, v236, v237
    v_max3_f32 v44, v44, v240, v241
    v_max3_f32 v40, v40, v234, v235
    v_max3_f32 v42, v42, v238, v239
    v_max3_f32 v44, v44, v242, v243
    v_max3_f32 v40, v40, v244, v245
    v_max3_f32 v42, v42, v248, v249
    v_max3_f32 v44, v44, v252, v253
    v_max3_f32 v40, v40, v246, v247
    v_max3_f32 v42, v42, v250, v251
    v_max3_f32 v44, v44, v254, v255
    v_mov_b32 v41, v40
    v_mov_b32 v43, v42
    v_mov_b32 v45, v44
    v_permlane32_swap_b32 v41, v40
    v_permlane32_swap_b32 v43, v42
    v_permlane32_swap_b32 v45, v44
    v_max_f32 v40, v40, v41
    v_max_f32 v42, v42, v43
    v_max_f32 v44, v44, v45
    v_mov_b32 v41, v40
    v_mov_b32 v43, v42
    v_mov_b32 v45, v44
    v_permlane16_swap_b32 v41, v40
    v_permlane16_swap_b32 v43, v42
    v_permlane16_swap_b32 v45, v44
    v_max_f32 v40, v40, v41
    v_max_f32 v42, v42, v43
    v_max_f32 v44, v44, v45
    v_sub_f32_e64 v46, -v16, v40
    v_sub_f32_e64 v48, -v20, v42
    v_sub_f32_e64 v50, -v24, v44
    v_exp_f32 v46, v46
    v_exp_f32 v48, v48
    v_exp_f32 v50, v50
    v_sub_f32 v16, 0, v40
    v_sub_f32 v17, 0, v40
    v_sub_f32 v18, 0, v40
    v_sub_f32 v19, 0, v40
    v_sub_f32 v20, 0, v42
    v_sub_f32 v21, 0, v42
    v_sub_f32 v22, 0, v42
    v_sub_f32 v23, 0, v42
    v_sub_f32 v24, 0, v44
    v_sub_f32 v25, 0, v44
    v_sub_f32 v26, 0, v44
    v_sub_f32 v27, 0, v44
    v_pk_add_f32 v[208:209], v[208:209], v[16:17]
    v_pk_add_f32 v[210:211], v[210:211], v[16:17]
    v_pk_add_f32 v[212:213], v[212:213], v[20:21]
    v_pk_add_f32 v[214:215], v[214:215], v[20:21]
    v_pk_add_f32 v[216:217], v[216:217], v[24:25]
    v_pk_add_f32 v[218:219], v[218:219], v[24:25]
    v_pk_add_f32 v[220:221], v[220:221], v[16:17]
    v_pk_add_f32 v[222:223], v[222:223], v[16:17]
    v_pk_add_f32 v[224:225], v[224:225], v[20:21]
    v_pk_add_f32 v[226:227], v[226:227], v[20:21]
    v_pk_add_f32 v[228:229], v[228:229], v[24:25]
    v_pk_add_f32 v[230:231], v[230:231], v[24:25]
    v_pk_add_f32 v[232:233], v[232:233], v[16:17]
    v_pk_add_f32 v[234:235], v[234:235], v[16:17]
    v_pk_add_f32 v[236:237], v[236:237], v[20:21]
    v_pk_add_f32 v[238:239], v[238:239], v[20:21]
    v_pk_add_f32 v[240:241], v[240:241], v[24:25]
    v_pk_add_f32 v[242:243], v[242:243], v[24:25]
    v_pk_add_f32 v[244:245], v[244:245], v[16:17]
    v_pk_add_f32 v[246:247], v[246:247], v[16:17]
    v_pk_add_f32 v[248:249], v[248:249], v[20:21]
    v_pk_add_f32 v[250:251], v[250:251], v[20:21]
    v_pk_add_f32 v[252:253], v[252:253], v[24:25]
    v_pk_add_f32 v[254:255], v[254:255], v[24:25]
    v_exp_f32 v208, v208
    v_exp_f32 v209, v209
    v_exp_f32 v210, v210
    v_exp_f32 v211, v211
    v_exp_f32 v212, v212
    v_exp_f32 v213, v213
    v_exp_f32 v214, v214
    v_exp_f32 v215, v215
    v_exp_f32 v216, v216
    v_exp_f32 v217, v217
    v_exp_f32 v218, v218
    v_exp_f32 v219, v219
    v_exp_f32 v220, v220
    v_exp_f32 v221, v221
    v_exp_f32 v222, v222
    v_exp_f32 v223, v223
    v_exp_f32 v224, v224
    v_exp_f32 v225, v225
    v_exp_f32 v226, v226
    v_exp_f32 v227, v227
    v_exp_f32 v228, v228
    v_exp_f32 v229, v229
    v_exp_f32 v230, v230
    v_exp_f32 v231, v231
    v_exp_f32 v232, v232
    v_exp_f32 v233, v233
    v_exp_f32 v234, v234
    v_exp_f32 v235, v235
    v_exp_f32 v236, v236
    v_exp_f32 v237, v237
    v_exp_f32 v238, v238
    v_exp_f32 v239, v239
    v_exp_f32 v240, v240
    v_exp_f32 v241, v241
    v_exp_f32 v242, v242
    v_exp_f32 v243, v243
    v_exp_f32 v244, v244
    v_exp_f32 v245, v245
    v_exp_f32 v246, v246
    v_exp_f32 v247, v247
    v_exp_f32 v248, v248
    v_exp_f32 v249, v249
    v_exp_f32 v250, v250
    v_exp_f32 v251, v251
    v_exp_f32 v252, v252
    v_exp_f32 v253, v253
    v_exp_f32 v254, v254
    v_exp_f32 v255, v255
    v_pk_mul_f32 v[2:3], v[2:3], v[46:47] op_sel_hi:[1,0]
    v_pk_mul_f32 v[64:65], v[64:65], v[46:47] op_sel_hi:[1,0]
    v_pk_mul_f32 v[66:67], v[66:67], v[46:47] op_sel_hi:[1,0]
    v_pk_mul_f32 v[76:77], v[76:77], v[46:47] op_sel_hi:[1,0]
    v_pk_mul_f32 v[78:79], v[78:79], v[46:47] op_sel_hi:[1,0]
    v_pk_mul_f32 v[88:89], v[88:89], v[46:47] op_sel_hi:[1,0]
    v_pk_mul_f32 v[90:91], v[90:91], v[46:47] op_sel_hi:[1,0]
    v_pk_mul_f32 v[100:101], v[100:101], v[46:47] op_sel_hi:[1,0]
    v_pk_mul_f32 v[102:103], v[102:103], v[46:47] op_sel_hi:[1,0]
    v_pk_mul_f32 v[112:113], v[112:113], v[46:47] op_sel_hi:[1,0]
    v_pk_mul_f32 v[114:115], v[114:115], v[46:47] op_sel_hi:[1,0]
    v_pk_mul_f32 v[124:125], v[124:125], v[46:47] op_sel_hi:[1,0]
    v_pk_mul_f32 v[126:127], v[126:127], v[46:47] op_sel_hi:[1,0]
    v_pk_mul_f32 v[136:137], v[136:137], v[46:47] op_sel_hi:[1,0]
    v_pk_mul_f32 v[138:139], v[138:139], v[46:47] op_sel_hi:[1,0]
    v_pk_mul_f32 v[148:149], v[148:149], v[46:47] op_sel_hi:[1,0]
    v_pk_mul_f32 v[150:151], v[150:151], v[46:47] op_sel_hi:[1,0]
    v_pk_mul_f32 v[28:29], v[28:29], v[48:49] op_sel_hi:[1,0]
    v_pk_mul_f32 v[68:69], v[68:69], v[48:49] op_sel_hi:[1,0]
    v_pk_mul_f32 v[70:71], v[70:71], v[48:49] op_sel_hi:[1,0]
    v_pk_mul_f32 v[80:81], v[80:81], v[48:49] op_sel_hi:[1,0]
    v_pk_mul_f32 v[82:83], v[82:83], v[48:49] op_sel_hi:[1,0]
    v_pk_mul_f32 v[92:93], v[92:93], v[48:49] op_sel_hi:[1,0]
    v_pk_mul_f32 v[94:95], v[94:95], v[48:49] op_sel_hi:[1,0]
    v_pk_mul_f32 v[104:105], v[104:105], v[48:49] op_sel_hi:[1,0]
    v_pk_mul_f32 v[106:107], v[106:107], v[48:49] op_sel_hi:[1,0]
    v_pk_mul_f32 v[116:117], v[116:117], v[48:49] op_sel_hi:[1,0]
    v_pk_mul_f32 v[118:119], v[118:119], v[48:49] op_sel_hi:[1,0]
    v_pk_mul_f32 v[128:129], v[128:129], v[48:49] op_sel_hi:[1,0]
    v_pk_mul_f32 v[130:131], v[130:131], v[48:49] op_sel_hi:[1,0]
    v_pk_mul_f32 v[140:141], v[140:141], v[48:49] op_sel_hi:[1,0]
    v_pk_mul_f32 v[142:143], v[142:143], v[48:49] op_sel_hi:[1,0]
    v_pk_mul_f32 v[152:153], v[152:153], v[48:49] op_sel_hi:[1,0]
    v_pk_mul_f32 v[154:155], v[154:155], v[48:49] op_sel_hi:[1,0]
    v_pk_mul_f32 v[30:31], v[30:31], v[50:51] op_sel_hi:[1,0]
    v_pk_mul_f32 v[72:73], v[72:73], v[50:51] op_sel_hi:[1,0]
    v_pk_mul_f32 v[74:75], v[74:75], v[50:51] op_sel_hi:[1,0]
    v_pk_mul_f32 v[84:85], v[84:85], v[50:51] op_sel_hi:[1,0]
    v_pk_mul_f32 v[86:87], v[86:87], v[50:51] op_sel_hi:[1,0]
    v_pk_mul_f32 v[96:97], v[96:97], v[50:51] op_sel_hi:[1,0]
    v_pk_mul_f32 v[98:99], v[98:99], v[50:51] op_sel_hi:[1,0]
    v_pk_mul_f32 v[108:109], v[108:109], v[50:51] op_sel_hi:[1,0]
    v_pk_mul_f32 v[110:111], v[110:111], v[50:51] op_sel_hi:[1,0]
    v_pk_mul_f32 v[120:121], v[120:121], v[50:51] op_sel_hi:[1,0]
    v_pk_mul_f32 v[122:123], v[122:123], v[50:51] op_sel_hi:[1,0]
    v_pk_mul_f32 v[132:133], v[132:133], v[50:51] op_sel_hi:[1,0]
    v_pk_mul_f32 v[134:135], v[134:135], v[50:51] op_sel_hi:[1,0]
    v_pk_mul_f32 v[144:145], v[144:145], v[50:51] op_sel_hi:[1,0]
    v_pk_mul_f32 v[146:147], v[146:147], v[50:51] op_sel_hi:[1,0]
    v_pk_mul_f32 v[156:157], v[156:157], v[50:51] op_sel_hi:[1,0]
    v_pk_mul_f32 v[158:159], v[158:159], v[50:51] op_sel_hi:[1,0]
    v_pk_add_f32 v[32:33], v[208:209], v[210:211]
    v_pk_add_f32 v[34:35], v[212:213], v[214:215]
    v_pk_add_f32 v[36:37], v[216:217], v[218:219]
    v_pk_add_f32 v[32:33], v[32:33], v[220:221]
    v_pk_add_f32 v[34:35], v[34:35], v[224:225]
    v_pk_add_f32 v[36:37], v[36:37], v[228:229]
    v_pk_add_f32 v[32:33], v[32:33], v[222:223]
    v_pk_add_f32 v[34:35], v[34:35], v[226:227]
    v_pk_add_f32 v[36:37], v[36:37], v[230:231]
    v_pk_add_f32 v[32:33], v[32:33], v[232:233]
    v_pk_add_f32 v[34:35], v[34:35], v[236:237]
    v_pk_add_f32 v[36:37], v[36:37], v[240:241]
    v_pk_add_f32 v[32:33], v[32:33], v[234:235]
    v_pk_add_f32 v[34:35], v[34:35], v[238:239]
    v_pk_add_f32 v[36:37], v[36:37], v[242:243]
    v_pk_add_f32 v[32:33], v[32:33], v[244:245]
    v_pk_add_f32 v[34:35], v[34:35], v[248:249]
    v_pk_add_f32 v[36:37], v[36:37], v[252:253]
    v_pk_add_f32 v[32:33], v[32:33], v[246:247]
    v_pk_add_f32 v[34:35], v[34:35], v[250:251]
    v_pk_add_f32 v[36:37], v[36:37], v[254:255]
    v_cvt_pk_bf16_f32 v208, v208, v209
    v_cvt_pk_bf16_f32 v212, v212, v213
    v_cvt_pk_bf16_f32 v216, v216, v217
    v_cvt_pk_bf16_f32 v209, v210, v211
    v_cvt_pk_bf16_f32 v213, v214, v215
    v_cvt_pk_bf16_f32 v217, v218, v219
    v_cvt_pk_bf16_f32 v210, v220, v221
    v_cvt_pk_bf16_f32 v214, v224, v225
    v_cvt_pk_bf16_f32 v218, v228, v229
    v_cvt_pk_bf16_f32 v211, v222, v223
    v_cvt_pk_bf16_f32 v215, v226, v227
    v_cvt_pk_bf16_f32 v219, v230, v231
    s_branch L_join
L_attn:
    s_waitcnt lgkmcnt(5)
    v_mfma_f32_16x16x32_bf16 v[208:211], v[32:35], v[160:163], v[16:19]
    ds_read_b128 v[56:59], v14 offset:4096
    v_mfma_f32_16x16x32_bf16 v[212:215], v[32:35], v[176:179], v[20:23]
    v_mfma_f32_16x16x32_bf16 v[216:219], v[32:35], v[192:195], v[24:27]
    s_waitcnt lgkmcnt(5)
    v_mfma_f32_16x16x32_bf16 v[208:211], v[36:39], v[164:167], v[208:211]
    ds_read_b128 v[60:63], v15 offset:4096
    v_mfma_f32_16x16x32_bf16 v[212:215], v[36:39], v[180:183], v[212:215]
    v_mfma_f32_16x16x32_bf16 v[216:219], v[36:39], v[196:199], v[216:219]
    s_waitcnt lgkmcnt(5)
    v_mfma_f32_16x16x32_bf16 v[208:211], v[40:43], v[168:171], v[208:211]
    ds_read_b128 v[32:35], v12 offset:8192
    v_mfma_f32_16x16x32_bf16 v[212:215], v[40:43], v[184:187], v[212:215]
    v_mfma_f32_16x16x32_bf16 v[216:219], v[40:43], v[200:203], v[216:219]
    s_waitcnt lgkmcnt(5)
    v_mfma_f32_16x16x32_bf16 v[208:211], v[44:47], v[172:175], v[208:211]
    ds_read_b128 v[36:39], v13 offset:8192
    v_mfma_f32_16x16x32_bf16 v[212:215], v[44:47], v[188:191], v[212:215]
    v_mfma_f32_16x16x32_bf16 v[216:219], v[44:47], v[204:207], v[216:219]
    s_waitcnt lgkmcnt(5)
    v_mfma_f32_16x16x32_bf16 v[220:223], v[48:51], v[160:163], v[16:19]
    ds_read_b128 v[40:43], v14 offset:8192
    v_mfma_f32_16x16x32_bf16 v[224:227], v[48:51], v[176:179], v[20:23]
    v_mfma_f32_16x16x32_bf16 v[228:231], v[48:51], v[192:195], v[24:27]
    s_waitcnt lgkmcnt(5)
    v_exp_f32 v208, v208
    v_mfma_f32_16x16x32_bf16 v[220:223], v[52:55], v[164:167], v[220:223]
    ds_read_b128 v[44:47], v15 offset:8192
    v_exp_f32 v209, v209
    v_mfma_f32_16x16x32_bf16 v[224:227], v[52:55], v[180:183], v[224:227]
    v_exp_f32 v210, v210
    v_mfma_f32_16x16x32_bf16 v[228:231], v[52:55], v[196:199], v[228:231]
    s_waitcnt lgkmcnt(5)
    v_exp_f32 v211, v211
    v_mfma_f32_16x16x32_bf16 v[220:223], v[56:59], v[168:171], v[220:223]
    ds_read_b128 v[48:51], v12 offset:12288
    v_exp_f32 v212, v212
    v_mfma_f32_16x16x32_bf16 v[224:227], v[56:59], v[184:187], v[224:227]
    v_exp_f32 v213, v213
    v_mfma_f32_16x16x32_bf16 v[228:231], v[56:59], v[200:203], v[228:231]
    s_waitcnt lgkmcnt(5)
    v_exp_f32 v214, v214
    v_mfma_f32_16x16x32_bf16 v[220:223], v[60:63], v[172:175], v[220:223]
    ds_read_b128 v[52:55], v13 offset:12288
    v_exp_f32 v215, v215
    v_mfma_f32_16x16x32_bf16 v[224:227], v[60:63], v[188:191], v[224:227]
    v_exp_f32 v216, v216
    v_mfma_f32_16x16x32_bf16 v[228:231], v[60:63], v[204:207], v[228:231]
    s_waitcnt lgkmcnt(5)
    v_exp_f32 v217, v217
    v_mfma_f32_16x16x32_bf16 v[232:235], v[32:35], v[160:163], v[16:19]
    ds_read_b128 v[56:59], v14 offset:12288
    v_exp_f32 v218, v218
    v_mfma_f32_16x16x32_bf16 v[236:239], v[32:35], v[176:179], v[20:23]
    v_exp_f32 v219, v219
    v_mfma_f32_16x16x32_bf16 v[240:243], v[32:35], v[192:195], v[24:27]
    s_waitcnt lgkmcnt(5)
    v_exp_f32 v220, v220
    v_mfma_f32_16x16x32_bf16 v[232:235], v[36:39], v[164:167], v[232:235]
    ds_read_b128 v[60:63], v15 offset:12288
    v_exp_f32 v221, v221
    v_mfma_f32_16x16x32_bf16 v[236:239], v[36:39], v[180:183], v[236:239]
    v_exp_f32 v222, v222
    v_mfma_f32_16x16x32_bf16 v[240:243], v[36:39], v[196:199], v[240:243]
    s_waitcnt lgkmcnt(5)
    v_exp_f32 v223, v223
    v_mfma_f32_16x16x32_bf16 v[232:235], v[40:43], v[168:171], v[232:235]
    v_exp_f32 v224, v224
    v_mfma_f32_16x16x32_bf16 v[236:239], v[40:43], v[184:187], v[236:239]
    v_exp_f32 v225, v225
    v_mfma_f32_16x16x32_bf16 v[240:243], v[40:43], v[200:203], v[240:243]
    s_waitcnt lgkmcnt(4)
    v_exp_f32 v226, v226
    v_mfma_f32_16x16x32_bf16 v[232:235], v[44:47], v[172:175], v[232:235]
    v_exp_f32 v227, v227
    v_mfma_f32_16x16x32_bf16 v[236:239], v[44:47], v[188:191], v[236:239]
    v_exp_f32 v228, v228
    v_mfma_f32_16x16x32_bf16 v[240:243], v[44:47], v[204:207], v[240:243]
    s_waitcnt lgkmcnt(3)
    v_exp_f32 v229, v229
    v_mfma_f32_16x16x32_bf16 v[244:247], v[48:51], v[160:163], v[16:19]
    v_exp_f32 v230, v230
    v_mfma_f32_16x16x32_bf16 v[248:251], v[48:51], v[176:179], v[20:23]
    v_exp_f32 v231, v231
    v_mfma_f32_16x16x32_bf16 v[252:255], v[48:51], v[192:195], v[24:27]
    s_waitcnt lgkmcnt(2)
    v_exp_f32 v232, v232
    v_mfma_f32_16x16x32_bf16 v[244:247], v[52:55], v[164:167], v[244:247]
    v_exp_f32 v233, v233
    v_mfma_f32_16x16x32_bf16 v[248:251], v[52:55], v[180:183], v[248:251]
    v_exp_f32 v234, v234
    v_mfma_f32_16x16x32_bf16 v[252:255], v[52:55], v[196:199], v[252:255]
    s_waitcnt lgkmcnt(1)
    v_exp_f32 v235, v235
    v_mfma_f32_16x16x32_bf16 v[244:247], v[56:59], v[168:171], v[244:247]
    v_exp_f32 v236, v236
    v_mfma_f32_16x16x32_bf16 v[248:251], v[56:59], v[184:187], v[248:251]
    v_exp_f32 v237, v237
    v_mfma_f32_16x16x32_bf16 v[252:255], v[56:59], v[200:203], v[252:255]
    s_waitcnt lgkmcnt(0)
    v_exp_f32 v238, v238
    v_mfma_f32_16x16x32_bf16 v[244:247], v[60:63], v[172:175], v[244:247]
    v_exp_f32 v239, v239
    v_mfma_f32_16x16x32_bf16 v[248:251], v[60:63], v[188:191], v[248:251]
    v_exp_f32 v240, v240
    v_mfma_f32_16x16x32_bf16 v[252:255], v[60:63], v[204:207], v[252:255]
    v_exp_f32 v241, v241
    v_exp_f32 v242, v242
    v_exp_f32 v243, v243
    v_pk_add_f32 v[32:33], v[208:209], v[210:211]
    v_pk_add_f32 v[34:35], v[212:213], v[214:215]
    v_pk_add_f32 v[36:37], v[216:217], v[218:219]
    v_pk_add_f32 v[32:33], v[32:33], v[220:221]
    v_pk_add_f32 v[34:35], v[34:35], v[224:225]
    v_pk_add_f32 v[36:37], v[36:37], v[228:229]
    v_pk_add_f32 v[32:33], v[32:33], v[222:223]
    v_pk_add_f32 v[34:35], v[34:35], v[226:227]
    v_pk_add_f32 v[36:37], v[36:37], v[230:231]
    v_cvt_pk_bf16_f32 v208, v208, v209
    v_cvt_pk_bf16_f32 v212, v212, v213
    v_cvt_pk_bf16_f32 v216, v216, v217
    v_cvt_pk_bf16_f32 v209, v210, v211
    v_cvt_pk_bf16_f32 v213, v214, v215
    v_cvt_pk_bf16_f32 v217, v218, v219
    v_cvt_pk_bf16_f32 v210, v220, v221
    v_cvt_pk_bf16_f32 v214, v224, v225
    v_cvt_pk_bf16_f32 v218, v228, v229
    v_cvt_pk_bf16_f32 v211, v222, v223
    v_cvt_pk_bf16_f32 v215, v226, v227
    v_cvt_pk_bf16_f32 v219, v230, v231
    v_exp_f32 v244, v244
    v_exp_f32 v245, v245
    v_exp_f32 v246, v246
    v_exp_f32 v247, v247
    v_exp_f32 v248, v248
    v_exp_f32 v249, v249
    v_exp_f32 v250, v250
    v_exp_f32 v251, v251
    v_exp_f32 v252, v252
    v_exp_f32 v253, v253
    v_exp_f32 v254, v254
    v_exp_f32 v255, v255
    v_pk_add_f32 v[32:33], v[32:33], v[232:233]
    v_pk_add_f32 v[34:35], v[34:35], v[236:237]
    v_pk_add_f32 v[36:37], v[36:37], v[240:241]
    v_pk_add_f32 v[32:33], v[32:33], v[234:235]
    v_pk_add_f32 v[34:35], v[34:35], v[238:239]
    v_pk_add_f32 v[36:37], v[36:37], v[242:243]
    v_pk_add_f32 v[32:33], v[32:33], v[244:245]
    v_pk_add_f32 v[34:35], v[34:35], v[248:249]
    v_pk_add_f32 v[36:37], v[36:37], v[252:253]
    v_pk_add_f32 v[32:33], v[32:33], v[246:247]
    v_pk_add_f32 v[34:35], v[34:35], v[250:251]
    v_pk_add_f32 v[36:37], v[36:37], v[254:255]
    v_max3_f32 v38, v32, v33, v34
    v_max3_f32 v39, v35, v36, v37
    v_max_f32 v38, v38, v39
    v_cmp_lt_f32 vcc, s78, v38
    s_cmp_eq_u32 s60, 0
    s_nop 3
    s_cbranch_vccnz L_exact
L_join:
    v_pk_add_f32 v[2:3], v[2:3], v[32:33]
    v_pk_add_f32 v[28:29], v[28:29], v[34:35]
    v_pk_add_f32 v[30:31], v[30:31], v[36:37]
    s_cmp_eq_u32 s60, 7
    s_barrier
    s_cbranch_scc1 L_attn_end
    ds_read_b64_tr_b16 v[32:33], v4 offset:0
    ds_read_b64_tr_b16 v[34:35], v4 offset:4096
    ds_read_b64_tr_b16 v[36:37], v5 offset:0
    ds_read_b64_tr_b16 v[38:39], v5 offset:4096
    ds_read_b64_tr_b16 v[40:41], v6 offset:0
    ds_read_b64_tr_b16 v[42:43], v6 offset:4096
    ds_read_b64_tr_b16 v[44:45], v7 offset:0
    ds_read_b64_tr_b16 v[46:47], v7 offset:4096
    ds_read_b64_tr_b16 v[48:49], v8 offset:0
    ds_read_b64_tr_b16 v[50:51], v8 offset:4096
    ds_read_b64_tr_b16 v[52:53], v9 offset:0
    ds_read_b64_tr_b16 v[54:55], v9 offset:4096
    v_cvt_pk_bf16_f32 v232, v232, v233
    v_cvt_pk_bf16_f32 v236, v236, v237
    v_cvt_pk_bf16_f32 v240, v240, v241
    v_cvt_pk_bf16_f32 v233, v234, v235
    v_cvt_pk_bf16_f32 v237, v238, v239
    v_cvt_pk_bf16_f32 v241, v242, v243
    v_cvt_pk_bf16_f32 v234, v244, v245
    v_cvt_pk_bf16_f32 v238, v248, v249
    v_cvt_pk_bf16_f32 v242, v252, v253
    v_cvt_pk_bf16_f32 v235, v246, v247
    v_cvt_pk_bf16_f32 v239, v250, v251
    v_cvt_pk_bf16_f32 v243, v254, v255
    s_waitcnt lgkmcnt(10)
    v_mfma_f32_16x16x32_bf16 v[64:67], v[32:35], v[208:211], v[64:67]
    ds_read_b64_tr_b16 v[56:57], v10 offset:0
    s_add_u32 s60, s60, 1
    v_mfma_f32_16x16x32_bf16 v[68:71], v[32:35], v[212:215], v[68:71]
    ds_read_b64_tr_b16 v[58:59], v10 offset:4096
    s_cmp_lt_u32 s60, 8
    v_mfma_f32_16x16x32_bf16 v[72:75], v[32:35], v[216:219], v[72:75]
    s_waitcnt lgkmcnt(10)
    v_xor_b32 v12, s65, v12
    v_mfma_f32_16x16x32_bf16 v[76:79], v[36:39], v[208:211], v[76:79]
    ds_read_b64_tr_b16 v[60:61], v11 offset:0
    s_cselect_b32 s63, s76, s66
    v_mfma_f32_16x16x32_bf16 v[80:83], v[36:39], v[212:215], v[80:83]
    ds_read_b64_tr_b16 v[62:63], v11 offset:4096
    s_mov_b32 s76, s77
    v_mfma_f32_16x16x32_bf16 v[84:87], v[36:39], v[216:219], v[84:87]
    s_waitcnt lgkmcnt(10)
    v_xor_b32 v13, s65, v13
    v_mfma_f32_16x16x32_bf16 v[88:91], v[40:43], v[208:211], v[88:91]
    ds_read_b64_tr_b16 v[32:33], v4 offset:8192
    s_mov_b32 s77, s71
    v_mfma_f32_16x16x32_bf16 v[92:95], v[40:43], v[212:215], v[92:95]
    ds_read_b64_tr_b16 v[34:35], v4 offset:12288
    s_mov_b32 s71, s63
    v_mfma_f32_16x16x32_bf16 v[96:99], v[40:43], v[216:219], v[96:99]
    s_waitcnt lgkmcnt(10)
    v_xor_b32 v14, s65, v14
    v_mfma_f32_16x16x32_bf16 v[100:103], v[44:47], v[208:211], v[100:103]
    ds_read_b64_tr_b16 v[36:37], v5 offset:8192
    v_mfma_f32_16x16x32_bf16 v[104:107], v[44:47], v[212:215], v[104:107]
    ds_read_b64_tr_b16 v[38:39], v5 offset:12288
    v_xor_b32 v4, s63, v4
    v_mfma_f32_16x16x32_bf16 v[108:111], v[44:47], v[216:219], v[108:111]
    s_waitcnt lgkmcnt(10)
    v_xor_b32 v15, s65, v15
    v_mfma_f32_16x16x32_bf16 v[112:115], v[48:51], v[208:211], v[112:115]
    ds_read_b64_tr_b16 v[40:41], v6 offset:8192
    v_mfma_f32_16x16x32_bf16 v[116:119], v[48:51], v[212:215], v[116:119]
    ds_read_b64_tr_b16 v[42:43], v6 offset:12288
    v_xor_b32 v5, s63, v5
    v_mfma_f32_16x16x32_bf16 v[120:123], v[48:51], v[216:219], v[120:123]
    s_waitcnt lgkmcnt(10)
    v_mfma_f32_16x16x32_bf16 v[124:127], v[52:55], v[208:211], v[124:127]
    ds_read_b64_tr_b16 v[44:45], v7 offset:8192
    v_mfma_f32_16x16x32_bf16 v[128:131], v[52:55], v[212:215], v[128:131]
    ds_read_b64_tr_b16 v[46:47], v7 offset:12288
    v_xor_b32 v6, s63, v6
    v_mfma_f32_16x16x32_bf16 v[132:135], v[52:55], v[216:219], v[132:135]
    s_waitcnt lgkmcnt(10)
    v_mfma_f32_16x16x32_bf16 v[136:139], v[56:59], v[208:211], v[136:139]
    ds_read_b64_tr_b16 v[48:49], v8 offset:8192
    v_mfma_f32_16x16x32_bf16 v[140:143], v[56:59], v[212:215], v[140:143]
    ds_read_b64_tr_b16 v[50:51], v8 offset:12288
    v_xor_b32 v7, s63, v7
    v_mfma_f32_16x16x32_bf16 v[144:147], v[56:59], v[216:219], v[144:147]
    s_waitcnt lgkmcnt(10)
    v_mfma_f32_16x16x32_bf16 v[148:151], v[60:63], v[208:211], v[148:151]
    ds_read_b64_tr_b16 v[52:53], v9 offset:8192
    v_mfma_f32_16x16x32_bf16 v[152:155], v[60:63], v[212:215], v[152:155]
    ds_read_b64_tr_b16 v[54:55], v9 offset:12288
    v_xor_b32 v8, s63, v8
    v_mfma_f32_16x16x32_bf16 v[156:159], v[60:63], v[216:219], v[156:159]
    s_waitcnt lgkmcnt(10)
    v_mfma_f32_16x16x32_bf16 v[64:67], v[32:35], v[232:235], v[64:67]
    ds_read_b64_tr_b16 v[56:57], v10 offset:8192
    v_mfma_f32_16x16x32_bf16 v[68:71], v[32:35], v[236:239], v[68:71]
    ds_read_b64_tr_b16 v[58:59], v10 offset:12288
    v_xor_b32 v9, s63, v9
    v_mfma_f32_16x16x32_bf16 v[72:75], v[32:35], v[240:243], v[72:75]
    s_waitcnt lgkmcnt(10)
    v_mfma_f32_16x16x32_bf16 v[76:79], v[36:39], v[232:235], v[76:79]
    ds_read_b64_tr_b16 v[60:61], v11 offset:8192
    v_mfma_f32_16x16x32_bf16 v[80:83], v[36:39], v[236:239], v[80:83]
    ds_read_b64_tr_b16 v[62:63], v11 offset:12288
    v_xor_b32 v10, s63, v10
    v_mfma_f32_16x16x32_bf16 v[84:87], v[36:39], v[240:243], v[84:87]
    s_waitcnt lgkmcnt(10)
    s_barrier
    v_mfma_f32_16x16x32_bf16 v[88:91], v[40:43], v[232:235], v[88:91]
    ds_read_b128 v[32:35], v12 offset:0
    v_mfma_f32_16x16x32_bf16 v[92:95], v[40:43], v[236:239], v[92:95]
    v_xor_b32 v11, s63, v11
    v_mfma_f32_16x16x32_bf16 v[96:99], v[40:43], v[240:243], v[96:99]
    s_waitcnt lgkmcnt(9)
    v_mfma_f32_16x16x32_bf16 v[100:103], v[44:47], v[232:235], v[100:103]
    ds_read_b128 v[36:39], v13 offset:0
    v_mfma_f32_16x16x32_bf16 v[104:107], v[44:47], v[236:239], v[104:107]
    v_mfma_f32_16x16x32_bf16 v[108:111], v[44:47], v[240:243], v[108:111]
    s_waitcnt lgkmcnt(8)
    v_mfma_f32_16x16x32_bf16 v[112:115], v[48:51], v[232:235], v[112:115]
    ds_read_b128 v[40:43], v14 offset:0
    v_mfma_f32_16x16x32_bf16 v[116:119], v[48:51], v[236:239], v[116:119]
    v_mfma_f32_16x16x32_bf16 v[120:123], v[48:51], v[240:243], v[120:123]
    s_waitcnt lgkmcnt(7)
    v_mfma_f32_16x16x32_bf16 v[124:127], v[52:55], v[232:235], v[124:127]
    ds_read_b128 v[44:47], v15 offset:0
    v_mfma_f32_16x16x32_bf16 v[128:131], v[52:55], v[236:239], v[128:131]
    v_mfma_f32_16x16x32_bf16 v[132:135], v[52:55], v[240:243], v[132:135]
    s_waitcnt lgkmcnt(6)
    v_mfma_f32_16x16x32_bf16 v[136:139], v[56:59], v[232:235], v[136:139]
    ds_read_b128 v[48:51], v12 offset:4096
    v_mfma_f32_16x16x32_bf16 v[140:143], v[56:59], v[236:239], v[140:143]
    v_mfma_f32_16x16x32_bf16 v[144:147], v[56:59], v[240:243], v[144:147]
    s_waitcnt lgkmcnt(5)
    v_mfma_f32_16x16x32_bf16 v[148:151], v[60:63], v[232:235], v[148:151]
    ds_read_b128 v[52:55], v13 offset:4096
    v_mfma_f32_16x16x32_bf16 v[152:155], v[60:63], v[236:239], v[152:155]
    v_mfma_f32_16x16x32_bf16 v[156:159], v[60:63], v[240:243], v[156:159]
    s_branch L_attn
L_attn_end:
    ds_read_b64_tr_b16 v[32:33], v4 offset:0
    ds_read_b64_tr_b16 v[34:35], v4 offset:4096
    ds_read_b64_tr_b16 v[36:37], v5 offset:0
    ds_read_b64_tr_b16 v[38:39], v5 offset:4096
    ds_read_b64_tr_b16 v[40:41], v6 offset:0
    ds_read_b64_tr_b16 v[42:43], v6 offset:4096
    ds_read_b64_tr_b16 v[44:45], v7 offset:0
    ds_read_b64_tr_b16 v[46:47], v7 offset:4096
    ds_read_b64_tr_b16 v[48:49], v4 offset:8192
    ds_read_b64_tr_b16 v[50:51], v4 offset:12288
    ds_read_b64_tr_b16 v[52:53], v5 offset:8192
    ds_read_b64_tr_b16 v[54:55], v5 offset:12288
    v_cvt_pk_bf16_f32 v232, v232, v233
    v_cvt_pk_bf16_f32 v236, v236, v237
    v_cvt_pk_bf16_f32 v240, v240, v241
    v_cvt_pk_bf16_f32 v233, v234, v235
    v_cvt_pk_bf16_f32 v237, v238, v239
    v_cvt_pk_bf16_f32 v241, v242, v243
    v_cvt_pk_bf16_f32 v234, v244, v245
    v_cvt_pk_bf16_f32 v238, v248, v249
    v_cvt_pk_bf16_f32 v242, v252, v253
    v_cvt_pk_bf16_f32 v235, v246, v247
    v_cvt_pk_bf16_f32 v239, v250, v251
    v_cvt_pk_bf16_f32 v243, v254, v255
    v_add_f32 v220, v2, v3
    v_add_f32 v224, v28, v29
    v_add_f32 v228, v30, v31
    v_mov_b32 v221, v220
    v_mov_b32 v225, v224
    v_mov_b32 v229, v228
    s_waitcnt lgkmcnt(10)
    v_mfma_f32_16x16x32_bf16 v[64:67], v[32:35], v[208:211], v[64:67]
    ds_read_b64_tr_b16 v[56:57], v6 offset:8192
    s_lshl2_add_u32 s57, s53, s56
    s_lshl2_add_u32 s57, s57, s52
    v_mfma_f32_16x16x32_bf16 v[68:71], v[32:35], v[212:215], v[68:71]
    ds_read_b64_tr_b16 v[58:59], v6 offset:12288
    s_lshl2_add_u32 s57, s57, s54
    s_lshl3_add_u32 s57, s57, s55
    v_mfma_f32_16x16x32_bf16 v[72:75], v[32:35], v[216:219], v[72:75]
    s_waitcnt lgkmcnt(10)
    v_permlane32_swap_b32 v221, v220
    v_mfma_f32_16x16x32_bf16 v[76:79], v[36:39], v[208:211], v[76:79]
    ds_read_b64_tr_b16 v[60:61], v7 offset:8192
    v_xor_b32 v4, s66, v4
    v_mfma_f32_16x16x32_bf16 v[80:83], v[36:39], v[212:215], v[80:83]
    ds_read_b64_tr_b16 v[62:63], v7 offset:12288
    v_xor_b32 v5, s66, v5
    v_mfma_f32_16x16x32_bf16 v[84:87], v[36:39], v[216:219], v[84:87]
    s_waitcnt lgkmcnt(10)
    v_permlane32_swap_b32 v225, v224
    v_mfma_f32_16x16x32_bf16 v[88:91], v[40:43], v[208:211], v[88:91]
    ds_read_b64_tr_b16 v[32:33], v8 offset:0
    v_xor_b32 v6, s66, v6
    v_mfma_f32_16x16x32_bf16 v[92:95], v[40:43], v[212:215], v[92:95]
    ds_read_b64_tr_b16 v[34:35], v8 offset:4096
    v_xor_b32 v7, s66, v7
    v_mfma_f32_16x16x32_bf16 v[96:99], v[40:43], v[216:219], v[96:99]
    s_waitcnt lgkmcnt(10)
    v_permlane32_swap_b32 v229, v228
    v_mfma_f32_16x16x32_bf16 v[100:103], v[44:47], v[208:211], v[100:103]
    ds_read_b64_tr_b16 v[36:37], v9 offset:0
    v_add_f32 v220, v220, v221
    v_mfma_f32_16x16x32_bf16 v[104:107], v[44:47], v[212:215], v[104:107]
    ds_read_b64_tr_b16 v[38:39], v9 offset:4096
    v_add_f32 v224, v224, v225
    v_mfma_f32_16x16x32_bf16 v[108:111], v[44:47], v[216:219], v[108:111]
    s_waitcnt lgkmcnt(10)
    v_add_f32 v228, v228, v229
    v_mov_b32 v221, v220
    v_mfma_f32_16x16x32_bf16 v[64:67], v[48:51], v[232:235], v[64:67]
    ds_read_b64_tr_b16 v[40:41], v10 offset:0
    v_mov_b32 v225, v224
    v_mfma_f32_16x16x32_bf16 v[68:71], v[48:51], v[236:239], v[68:71]
    ds_read_b64_tr_b16 v[42:43], v10 offset:4096
    v_mov_b32 v229, v228
    v_mfma_f32_16x16x32_bf16 v[72:75], v[48:51], v[240:243], v[72:75]
    s_waitcnt lgkmcnt(10)
    v_permlane16_swap_b32 v221, v220
    v_mfma_f32_16x16x32_bf16 v[76:79], v[52:55], v[232:235], v[76:79]
    ds_read_b64_tr_b16 v[44:45], v11 offset:0
    v_lshlrev_b32 v22, 4, v1
    v_mfma_f32_16x16x32_bf16 v[80:83], v[52:55], v[236:239], v[80:83]
    ds_read_b64_tr_b16 v[46:47], v11 offset:4096
    v_mov_b32 v24, 81936
    v_mfma_f32_16x16x32_bf16 v[84:87], v[52:55], v[240:243], v[84:87]
    s_waitcnt lgkmcnt(10)
    v_permlane16_swap_b32 v225, v224
    v_mfma_f32_16x16x32_bf16 v[88:91], v[56:59], v[232:235], v[88:91]
    ds_read_b64_tr_b16 v[48:49], v8 offset:8192
    s_mul_i32 s57, s57, 12288
    s_add_u32 s76, s57, 0
    v_mfma_f32_16x16x32_bf16 v[92:95], v[56:59], v[236:239], v[92:95]
    ds_read_b64_tr_b16 v[50:51], v8 offset:12288
    v_xor_b32 v8, s66, v8
    v_mfma_f32_16x16x32_bf16 v[96:99], v[56:59], v[240:243], v[96:99]
    s_waitcnt lgkmcnt(10)
    v_permlane16_swap_b32 v229, v228
    v_mfma_f32_16x16x32_bf16 v[100:103], v[60:63], v[232:235], v[100:103]
    ds_read_b64_tr_b16 v[52:53], v9 offset:8192
    v_add_f32 v220, v220, v221
    v_mfma_f32_16x16x32_bf16 v[104:107], v[60:63], v[236:239], v[104:107]
    ds_read_b64_tr_b16 v[54:55], v9 offset:12288
    v_add_f32 v224, v224, v225
    v_xor_b32 v9, s66, v9
    v_mfma_f32_16x16x32_bf16 v[108:111], v[60:63], v[240:243], v[108:111]
    s_waitcnt lgkmcnt(10)
    v_add_f32 v228, v228, v229
    v_rcp_f32 v220, v220
    v_mfma_f32_16x16x32_bf16 v[112:115], v[32:35], v[208:211], v[112:115]
    ds_read_b64_tr_b16 v[56:57], v10 offset:8192
    v_rcp_f32 v224, v224
    v_mfma_f32_16x16x32_bf16 v[116:119], v[32:35], v[212:215], v[116:119]
    ds_read_b64_tr_b16 v[58:59], v10 offset:12288
    v_xor_b32 v10, s66, v10
    v_mfma_f32_16x16x32_bf16 v[120:123], v[32:35], v[216:219], v[120:123]
    s_waitcnt lgkmcnt(10)
    v_rcp_f32 v228, v228
    v_mfma_f32_16x16x32_bf16 v[124:127], v[36:39], v[208:211], v[124:127]
    ds_read_b64_tr_b16 v[60:61], v11 offset:8192
    s_add_u32 s63, s76, 4096
    s_add_u32 s78, s76, 8192
    v_mfma_f32_16x16x32_bf16 v[128:131], v[36:39], v[212:215], v[128:131]
    ds_read_b64_tr_b16 v[62:63], v11 offset:12288
    v_xor_b32 v11, s66, v11
    v_mul_f32 v64, v64, v220
    v_mul_f32 v65, v65, v220
    v_mfma_f32_16x16x32_bf16 v[132:135], v[36:39], v[216:219], v[132:135]
    s_waitcnt lgkmcnt(10)
    v_mul_f32 v66, v66, v220
    v_mul_f32 v67, v67, v220
    v_mfma_f32_16x16x32_bf16 v[136:139], v[40:43], v[208:211], v[136:139]
    v_mul_f32 v76, v76, v220
    v_mul_f32 v77, v77, v220
    v_mfma_f32_16x16x32_bf16 v[140:143], v[40:43], v[212:215], v[140:143]
    v_mul_f32 v78, v78, v220
    v_mul_f32 v79, v79, v220
    v_mfma_f32_16x16x32_bf16 v[144:147], v[40:43], v[216:219], v[144:147]
    s_waitcnt lgkmcnt(8)
    v_cvt_pk_bf16_f32 v160, v64, v65
    v_cvt_pk_bf16_f32 v161, v66, v67
    v_mfma_f32_16x16x32_bf16 v[148:151], v[44:47], v[208:211], v[148:151]
    v_cvt_pk_bf16_f32 v162, v76, v77
    v_cvt_pk_bf16_f32 v163, v78, v79
    v_mfma_f32_16x16x32_bf16 v[152:155], v[44:47], v[212:215], v[152:155]
    buffer_store_dwordx4 v[160:163], v22, s[48:51], s76 offen offset:0
    v_mul_f32 v88, v88, v220
    v_mfma_f32_16x16x32_bf16 v[156:159], v[44:47], v[216:219], v[156:159]
    s_waitcnt lgkmcnt(6)
    v_mul_f32 v89, v89, v220
    v_mul_f32 v90, v90, v220
    v_mfma_f32_16x16x32_bf16 v[112:115], v[48:51], v[232:235], v[112:115]
    v_mul_f32 v91, v91, v220
    v_mul_f32 v100, v100, v220
    v_mfma_f32_16x16x32_bf16 v[116:119], v[48:51], v[236:239], v[116:119]
    v_mul_f32 v101, v101, v220
    v_mul_f32 v102, v102, v220
    v_mfma_f32_16x16x32_bf16 v[120:123], v[48:51], v[240:243], v[120:123]
    s_waitcnt lgkmcnt(4)
    v_mul_f32 v103, v103, v220
    v_cvt_pk_bf16_f32 v164, v88, v89
    v_mfma_f32_16x16x32_bf16 v[124:127], v[52:55], v[232:235], v[124:127]
    v_cvt_pk_bf16_f32 v165, v90, v91
    v_cvt_pk_bf16_f32 v166, v100, v101
    v_mfma_f32_16x16x32_bf16 v[128:131], v[52:55], v[236:239], v[128:131]
    v_cvt_pk_bf16_f32 v167, v102, v103
    buffer_store_dwordx4 v[164:167], v22, s[48:51], s76 offen offset:1024
    v_mfma_f32_16x16x32_bf16 v[132:135], v[52:55], v[240:243], v[132:135]
    s_waitcnt lgkmcnt(2)
    v_mul_f32 v68, v68, v224
    v_mul_f32 v69, v69, v224
    v_mfma_f32_16x16x32_bf16 v[136:139], v[56:59], v[232:235], v[136:139]
    v_mul_f32 v70, v70, v224
    v_mul_f32 v71, v71, v224
    v_mfma_f32_16x16x32_bf16 v[140:143], v[56:59], v[236:239], v[140:143]
    v_mul_f32 v80, v80, v224
    v_mul_f32 v81, v81, v224
    v_mfma_f32_16x16x32_bf16 v[144:147], v[56:59], v[240:243], v[144:147]
    s_waitcnt lgkmcnt(0)
    v_mul_f32 v82, v82, v224
    v_mul_f32 v83, v83, v224
    v_mfma_f32_16x16x32_bf16 v[148:151], v[60:63], v[232:235], v[148:151]
    v_cvt_pk_bf16_f32 v168, v68, v69
    v_cvt_pk_bf16_f32 v169, v70, v71
    v_mfma_f32_16x16x32_bf16 v[152:155], v[60:63], v[236:239], v[152:155]
    v_cvt_pk_bf16_f32 v170, v80, v81
    v_cvt_pk_bf16_f32 v171, v82, v83
    v_mfma_f32_16x16x32_bf16 v[156:159], v[60:63], v[240:243], v[156:159]
    buffer_store_dwordx4 v[168:171], v22, s[48:51], s76 offen offset:2048
    s_getreg_b32 s57, hwreg(HW_REG_XCC_ID, 0, 3)
    s_mul_i32 s58, s57, s57
    s_lshl_b32 s58, s58, 8
    s_add_u32 s58, s58, s57
    s_lshl_b32 s58, s58, 8
    s_add_u32 s58, s58, 1
    s_lshl_b32 s58, s58, 3
    v_pk_mul_f32 v[92:93], v[92:93], v[224:225] op_sel_hi:[1,0]
    v_pk_mul_f32 v[94:95], v[94:95], v[224:225] op_sel_hi:[1,0]
    v_pk_mul_f32 v[104:105], v[104:105], v[224:225] op_sel_hi:[1,0]
    v_pk_mul_f32 v[106:107], v[106:107], v[224:225] op_sel_hi:[1,0]
    v_cvt_pk_bf16_f32 v172, v92, v93
    v_cvt_pk_bf16_f32 v173, v94, v95
    v_cvt_pk_bf16_f32 v174, v104, v105
    v_cvt_pk_bf16_f32 v175, v106, v107
    buffer_store_dwordx4 v[172:175], v22, s[48:51], s76 offen offset:3072
    v_pk_mul_f32 v[72:73], v[72:73], v[228:229] op_sel_hi:[1,0]
    v_pk_mul_f32 v[74:75], v[74:75], v[228:229] op_sel_hi:[1,0]
    v_pk_mul_f32 v[84:85], v[84:85], v[228:229] op_sel_hi:[1,0]
    v_pk_mul_f32 v[86:87], v[86:87], v[228:229] op_sel_hi:[1,0]
    v_cvt_pk_bf16_f32 v176, v72, v73
    v_cvt_pk_bf16_f32 v177, v74, v75
    v_cvt_pk_bf16_f32 v178, v84, v85
    v_cvt_pk_bf16_f32 v179, v86, v87
    buffer_store_dwordx4 v[176:179], v22, s[48:51], s63 offen offset:0
    v_pk_mul_f32 v[96:97], v[96:97], v[228:229] op_sel_hi:[1,0]
    v_pk_mul_f32 v[98:99], v[98:99], v[228:229] op_sel_hi:[1,0]
    v_pk_mul_f32 v[108:109], v[108:109], v[228:229] op_sel_hi:[1,0]
    v_pk_mul_f32 v[110:111], v[110:111], v[228:229] op_sel_hi:[1,0]
    v_cvt_pk_bf16_f32 v180, v96, v97
    v_cvt_pk_bf16_f32 v181, v98, v99
    v_cvt_pk_bf16_f32 v182, v108, v109
    v_cvt_pk_bf16_f32 v183, v110, v111
    buffer_store_dwordx4 v[180:183], v22, s[48:51], s63 offen offset:1024
    v_pk_mul_f32 v[112:113], v[112:113], v[220:221] op_sel_hi:[1,0]
    v_pk_mul_f32 v[114:115], v[114:115], v[220:221] op_sel_hi:[1,0]
    v_pk_mul_f32 v[124:125], v[124:125], v[220:221] op_sel_hi:[1,0]
    v_pk_mul_f32 v[126:127], v[126:127], v[220:221] op_sel_hi:[1,0]
    v_cvt_pk_bf16_f32 v184, v112, v113
    v_cvt_pk_bf16_f32 v185, v114, v115
    v_cvt_pk_bf16_f32 v186, v124, v125
    v_cvt_pk_bf16_f32 v187, v126, v127
    v_pk_mul_f32 v[136:137], v[136:137], v[220:221] op_sel_hi:[1,0]
    v_pk_mul_f32 v[138:139], v[138:139], v[220:221] op_sel_hi:[1,0]
    v_pk_mul_f32 v[148:149], v[148:149], v[220:221] op_sel_hi:[1,0]
    v_pk_mul_f32 v[150:151], v[150:151], v[220:221] op_sel_hi:[1,0]
    v_cvt_pk_bf16_f32 v188, v136, v137
    v_cvt_pk_bf16_f32 v189, v138, v139
    v_cvt_pk_bf16_f32 v190, v148, v149
    v_cvt_pk_bf16_f32 v191, v150, v151
    v_pk_mul_f32 v[116:117], v[116:117], v[224:225] op_sel_hi:[1,0]
    v_pk_mul_f32 v[118:119], v[118:119], v[224:225] op_sel_hi:[1,0]
    v_pk_mul_f32 v[128:129], v[128:129], v[224:225] op_sel_hi:[1,0]
    v_pk_mul_f32 v[130:131], v[130:131], v[224:225] op_sel_hi:[1,0]
    v_cvt_pk_bf16_f32 v192, v116, v117
    v_cvt_pk_bf16_f32 v193, v118, v119
    v_cvt_pk_bf16_f32 v194, v128, v129
    v_cvt_pk_bf16_f32 v195, v130, v131
    v_pk_mul_f32 v[140:141], v[140:141], v[224:225] op_sel_hi:[1,0]
    v_pk_mul_f32 v[142:143], v[142:143], v[224:225] op_sel_hi:[1,0]
    v_pk_mul_f32 v[152:153], v[152:153], v[224:225] op_sel_hi:[1,0]
    v_pk_mul_f32 v[154:155], v[154:155], v[224:225] op_sel_hi:[1,0]
    v_cvt_pk_bf16_f32 v196, v140, v141
    v_cvt_pk_bf16_f32 v197, v142, v143
    v_cvt_pk_bf16_f32 v198, v152, v153
    v_cvt_pk_bf16_f32 v199, v154, v155
    v_pk_mul_f32 v[120:121], v[120:121], v[228:229] op_sel_hi:[1,0]
    v_pk_mul_f32 v[122:123], v[122:123], v[228:229] op_sel_hi:[1,0]
    v_pk_mul_f32 v[132:133], v[132:133], v[228:229] op_sel_hi:[1,0]
    v_pk_mul_f32 v[134:135], v[134:135], v[228:229] op_sel_hi:[1,0]
    v_cvt_pk_bf16_f32 v200, v120, v121
    v_cvt_pk_bf16_f32 v201, v122, v123
    v_cvt_pk_bf16_f32 v202, v132, v133
    v_cvt_pk_bf16_f32 v203, v134, v135
    v_pk_mul_f32 v[144:145], v[144:145], v[228:229] op_sel_hi:[1,0]
    v_pk_mul_f32 v[146:147], v[146:147], v[228:229] op_sel_hi:[1,0]
    v_pk_mul_f32 v[156:157], v[156:157], v[228:229] op_sel_hi:[1,0]
    v_pk_mul_f32 v[158:159], v[158:159], v[228:229] op_sel_hi:[1,0]
    v_cvt_pk_bf16_f32 v204, v144, v145
    v_cvt_pk_bf16_f32 v205, v146, v147
    v_cvt_pk_bf16_f32 v206, v156, v157
    v_cvt_pk_bf16_f32 v207, v158, v159
    s_barrier
    ds_read_b32 v25, v24
    ds_read_b64_tr_b16 v[32:33], v4 offset:0
    ds_read_b64_tr_b16 v[34:35], v4 offset:4096
    ds_read_b64_tr_b16 v[36:37], v5 offset:0
    ds_read_b64_tr_b16 v[38:39], v5 offset:4096
    ds_read_b64_tr_b16 v[40:41], v6 offset:0
    ds_read_b64_tr_b16 v[42:43], v6 offset:4096
    ds_read_b64_tr_b16 v[44:45], v7 offset:0
    ds_read_b64_tr_b16 v[46:47], v7 offset:4096
    ds_read_b64_tr_b16 v[48:49], v8 offset:0
    ds_read_b64_tr_b16 v[50:51], v8 offset:4096
    ds_read_b64_tr_b16 v[52:53], v9 offset:0
    ds_read_b64_tr_b16 v[54:55], v9 offset:4096
    s_waitcnt lgkmcnt(12)
    v_readfirstlane_b32 s71, v25
    s_nop 0
    s_cmp_eq_u32 s71, s58
    s_cselect_b32 s71, 0, 1
    s_cbranch_scc0 L_cv_far
L_cv_done:
    s_waitcnt lgkmcnt(10)
    v_mfma_f32_16x16x32_bf16 v[64:67], v[32:35], v[160:163], 0
    ds_read_b64_tr_b16 v[56:57], v10 offset:0
    v_mfma_f32_16x16x32_bf16 v[68:71], v[32:35], v[168:171], 0
    ds_read_b64_tr_b16 v[58:59], v10 offset:4096
    v_mfma_f32_16x16x32_bf16 v[72:75], v[32:35], v[176:179], 0
    s_waitcnt lgkmcnt(10)
    s_mul_i32 s57, s52, 6144
    s_add_u32 s57, s57, 16384
    v_mfma_f32_16x16x32_bf16 v[76:79], v[36:39], v[160:163], 0
    ds_read_b64_tr_b16 v[60:61], v11 offset:0
    s_lshl_b32 s64, s2, 3
    s_add_u32 s64, s64, s52
    v_mfma_f32_16x16x32_bf16 v[80:83], v[36:39], v[168:171], 0
    ds_read_b64_tr_b16 v[62:63], v11 offset:4096
    s_lshl_b32 s64, s64, 7
    s_add_u32 s64, s64, 33554432
    v_mfma_f32_16x16x32_bf16 v[84:87], v[36:39], v[176:179], 0
    s_waitcnt lgkmcnt(10)
    v_lshl_add_u32 v12, v1, 4, s57
    v_mfma_f32_16x16x32_bf16 v[88:91], v[40:43], v[160:163], 0
    ds_read_b64_tr_b16 v[32:33], v4 offset:8192
    v_mov_b32 v2, 0
    v_mfma_f32_16x16x32_bf16 v[92:95], v[40:43], v[168:171], 0
    ds_read_b64_tr_b16 v[34:35], v4 offset:12288
    v_mov_b32 v3, 1
    v_mfma_f32_16x16x32_bf16 v[96:99], v[40:43], v[176:179], 0
    s_waitcnt lgkmcnt(10)
    v_mfma_f32_16x16x32_bf16 v[100:103], v[44:47], v[160:163], 0
    ds_read_b64_tr_b16 v[36:37], v5 offset:8192
    s_mov_b32 s61, 1
    s_mov_b32 s62, 10
    v_mfma_f32_16x16x32_bf16 v[104:107], v[44:47], v[168:171], 0
    ds_read_b64_tr_b16 v[38:39], v5 offset:12288
    s_mov_b32 s70, 1
    v_mfma_f32_16x16x32_bf16 v[108:111], v[44:47], v[176:179], 0
    s_waitcnt lgkmcnt(10)
    v_add_u32 v13, 1024, v12
    v_mfma_f32_16x16x32_bf16 v[112:115], v[48:51], v[160:163], 0
    ds_read_b64_tr_b16 v[40:41], v6 offset:8192
    v_mfma_f32_16x16x32_bf16 v[116:119], v[48:51], v[168:171], 0
    ds_read_b64_tr_b16 v[42:43], v6 offset:12288
    s_mov_b32 s60, 0
    s_mov_b32 s58, 81920
    v_mfma_f32_16x16x32_bf16 v[120:123], v[48:51], v[176:179], 0
    s_waitcnt lgkmcnt(10)
    s_cmp_eq_u32 s71, 1
    s_cbranch_scc1 L_f0_far
    s_mov_b64 exec, 1
    s_waitcnt vmcnt(0)
    buffer_store_dword v3, v2, s[48:51], s64 offen
    s_mov_b64 exec, -1
L_f0_done:
    v_mfma_f32_16x16x32_bf16 v[124:127], v[52:55], v[160:163], 0
    ds_read_b64_tr_b16 v[44:45], v7 offset:8192
    v_mfma_f32_16x16x32_bf16 v[128:131], v[52:55], v[168:171], 0
    ds_read_b64_tr_b16 v[46:47], v7 offset:12288
    v_mfma_f32_16x16x32_bf16 v[132:135], v[52:55], v[176:179], 0
    s_waitcnt lgkmcnt(10)
    v_mfma_f32_16x16x32_bf16 v[136:139], v[56:59], v[160:163], 0
    ds_read_b64_tr_b16 v[48:49], v8 offset:8192
    v_mfma_f32_16x16x32_bf16 v[140:143], v[56:59], v[168:171], 0
    ds_read_b64_tr_b16 v[50:51], v8 offset:12288
    v_mfma_f32_16x16x32_bf16 v[144:147], v[56:59], v[176:179], 0
    s_waitcnt lgkmcnt(10)
    v_mfma_f32_16x16x32_bf16 v[148:151], v[60:63], v[160:163], 0
    ds_read_b64_tr_b16 v[52:53], v9 offset:8192
    v_mfma_f32_16x16x32_bf16 v[152:155], v[60:63], v[168:171], 0
    ds_read_b64_tr_b16 v[54:55], v9 offset:12288
    v_mfma_f32_16x16x32_bf16 v[156:159], v[60:63], v[176:179], 0
    s_waitcnt lgkmcnt(10)
    v_mfma_f32_16x16x32_bf16 v[64:67], v[32:35], v[164:167], v[64:67]
    ds_read_b64_tr_b16 v[56:57], v10 offset:8192
    v_mfma_f32_16x16x32_bf16 v[68:71], v[32:35], v[172:175], v[68:71]
    ds_read_b64_tr_b16 v[58:59], v10 offset:12288
    v_mfma_f32_16x16x32_bf16 v[72:75], v[32:35], v[180:183], v[72:75]
    s_waitcnt lgkmcnt(10)
    v_mfma_f32_16x16x32_bf16 v[76:79], v[36:39], v[164:167], v[76:79]
    ds_read_b64_tr_b16 v[60:61], v11 offset:8192
    v_mfma_f32_16x16x32_bf16 v[80:83], v[36:39], v[172:175], v[80:83]
    ds_read_b64_tr_b16 v[62:63], v11 offset:12288
    v_mfma_f32_16x16x32_bf16 v[84:87], v[36:39], v[180:183], v[84:87]
    s_waitcnt lgkmcnt(10)
    v_mfma_f32_16x16x32_bf16 v[88:91], v[40:43], v[164:167], v[88:91]
    ds_read_b64_tr_b16 v[32:33], v4 offset:16384
    v_mfma_f32_16x16x32_bf16 v[92:95], v[40:43], v[172:175], v[92:95]
    ds_read_b64_tr_b16 v[34:35], v4 offset:20480
    v_mfma_f32_16x16x32_bf16 v[96:99], v[40:43], v[180:183], v[96:99]
    s_waitcnt lgkmcnt(10)
    v_mfma_f32_16x16x32_bf16 v[100:103], v[44:47], v[164:167], v[100:103]
    ds_read_b64_tr_b16 v[36:37], v5 offset:16384
    v_mfma_f32_16x16x32_bf16 v[104:107], v[44:47], v[172:175], v[104:107]
    ds_read_b64_tr_b16 v[38:39], v5 offset:20480
    v_mfma_f32_16x16x32_bf16 v[108:111], v[44:47], v[180:183], v[108:111]
    s_waitcnt lgkmcnt(10)
    v_mfma_f32_16x16x32_bf16 v[112:115], v[48:51], v[164:167], v[112:115]
    ds_read_b64_tr_b16 v[40:41], v6 offset:16384
    v_mfma_f32_16x16x32_bf16 v[116:119], v[48:51], v[172:175], v[116:119]
    ds_read_b64_tr_b16 v[42:43], v6 offset:20480
    v_mfma_f32_16x16x32_bf16 v[120:123], v[48:51], v[180:183], v[120:123]
    s_waitcnt lgkmcnt(10)
    v_mfma_f32_16x16x32_bf16 v[124:127], v[52:55], v[164:167], v[124:127]
    ds_read_b64_tr_b16 v[44:45], v7 offset:16384
    v_mfma_f32_16x16x32_bf16 v[128:131], v[52:55], v[172:175], v[128:131]
    ds_read_b64_tr_b16 v[46:47], v7 offset:20480
    v_mfma_f32_16x16x32_bf16 v[132:135], v[52:55], v[180:183], v[132:135]
    s_waitcnt lgkmcnt(10)
    buffer_store_dwordx4 v[184:187], v22, s[48:51], s63 offen offset:2048
    v_mfma_f32_16x16x32_bf16 v[136:139], v[56:59], v[164:167], v[136:139]
    ds_read_b64_tr_b16 v[48:49], v8 offset:16384
    v_mfma_f32_16x16x32_bf16 v[140:143], v[56:59], v[172:175], v[140:143]
    ds_read_b64_tr_b16 v[50:51], v8 offset:20480
    v_mfma_f32_16x16x32_bf16 v[144:147], v[56:59], v[180:183], v[144:147]
    s_waitcnt lgkmcnt(10)
    v_mfma_f32_16x16x32_bf16 v[148:151], v[60:63], v[164:167], v[148:151]
    ds_read_b64_tr_b16 v[52:53], v9 offset:16384
    v_mfma_f32_16x16x32_bf16 v[152:155], v[60:63], v[172:175], v[152:155]
    ds_read_b64_tr_b16 v[54:55], v9 offset:20480
    v_mfma_f32_16x16x32_bf16 v[156:159], v[60:63], v[180:183], v[156:159]
    s_waitcnt lgkmcnt(10)
    buffer_store_dwordx4 v[188:191], v22, s[48:51], s63 offen offset:3072
    v_mfma_f32_16x16x32_bf16 v[64:67], v[32:35], v[184:187], v[64:67]
    ds_read_b64_tr_b16 v[56:57], v10 offset:16384
    v_mfma_f32_16x16x32_bf16 v[68:71], v[32:35], v[192:195], v[68:71]
    ds_read_b64_tr_b16 v[58:59], v10 offset:20480
    v_mfma_f32_16x16x32_bf16 v[72:75], v[32:35], v[200:203], v[72:75]
    s_waitcnt lgkmcnt(10)
    v_mfma_f32_16x16x32_bf16 v[76:79], v[36:39], v[184:187], v[76:79]
    ds_read_b64_tr_b16 v[60:61], v11 offset:16384
    v_mfma_f32_16x16x32_bf16 v[80:83], v[36:39], v[192:195], v[80:83]
    ds_read_b64_tr_b16 v[62:63], v11 offset:20480
    v_mfma_f32_16x16x32_bf16 v[84:87], v[36:39], v[200:203], v[84:87]
    s_waitcnt lgkmcnt(10)
    buffer_store_dwordx4 v[192:195], v22, s[48:51], s78 offen offset:0
    v_mfma_f32_16x16x32_bf16 v[88:91], v[40:43], v[184:187], v[88:91]
    ds_read_b64_tr_b16 v[32:33], v4 offset:24576
    v_mfma_f32_16x16x32_bf16 v[92:95], v[40:43], v[192:195], v[92:95]
    ds_read_b64_tr_b16 v[34:35], v4 offset:28672
    v_mfma_f32_16x16x32_bf16 v[96:99], v[40:43], v[200:203], v[96:99]
    s_waitcnt lgkmcnt(10)
    v_mfma_f32_16x16x32_bf16 v[100:103], v[44:47], v[184:187], v[100:103]
    ds_read_b64_tr_b16 v[36:37], v5 offset:24576
    v_mfma_f32_16x16x32_bf16 v[104:107], v[44:47], v[192:195], v[104:107]
    ds_read_b64_tr_b16 v[38:39], v5 offset:28672
    v_xor_b32 v4, 131072, v4
    v_mfma_f32_16x16x32_bf16 v[108:111], v[44:47], v[200:203], v[108:111]
    s_waitcnt lgkmcnt(10)
    buffer_store_dwordx4 v[196:199], v22, s[48:51], s78 offen offset:1024
    v_mfma_f32_16x16x32_bf16 v[112:115], v[48:51], v[184:187], v[112:115]
    ds_read_b64_tr_b16 v[40:41], v6 offset:24576
    v_mfma_f32_16x16x32_bf16 v[116:119], v[48:51], v[192:195], v[116:119]
    ds_read_b64_tr_b16 v[42:43], v6 offset:28672
    v_xor_b32 v5, 131072, v5
    v_mfma_f32_16x16x32_bf16 v[120:123], v[48:51], v[200:203], v[120:123]
    s_waitcnt lgkmcnt(10)
    v_mfma_f32_16x16x32_bf16 v[124:127], v[52:55], v[184:187], v[124:127]
    ds_read_b64_tr_b16 v[44:45], v7 offset:24576
    v_mfma_f32_16x16x32_bf16 v[128:131], v[52:55], v[192:195], v[128:131]
    ds_read_b64_tr_b16 v[46:47], v7 offset:28672
    v_xor_b32 v6, 131072, v6
    v_mfma_f32_16x16x32_bf16 v[132:135], v[52:55], v[200:203], v[132:135]
    s_waitcnt lgkmcnt(10)
    buffer_store_dwordx4 v[200:203], v22, s[48:51], s78 offen offset:2048
    v_mfma_f32_16x16x32_bf16 v[136:139], v[56:59], v[184:187], v[136:139]
    ds_read_b64_tr_b16 v[48:49], v8 offset:24576
    v_mfma_f32_16x16x32_bf16 v[140:143], v[56:59], v[192:195], v[140:143]
    ds_read_b64_tr_b16 v[50:51], v8 offset:28672
    v_xor_b32 v7, 131072, v7
    v_mfma_f32_16x16x32_bf16 v[144:147], v[56:59], v[200:203], v[144:147]
    s_waitcnt lgkmcnt(10)
    v_mfma_f32_16x16x32_bf16 v[148:151], v[60:63], v[184:187], v[148:151]
    ds_read_b64_tr_b16 v[52:53], v9 offset:24576
    v_mfma_f32_16x16x32_bf16 v[152:155], v[60:63], v[192:195], v[152:155]
    ds_read_b64_tr_b16 v[54:55], v9 offset:28672
    v_xor_b32 v8, 131072, v8
    v_mfma_f32_16x16x32_bf16 v[156:159], v[60:63], v[200:203], v[156:159]
    s_waitcnt lgkmcnt(10)
    buffer_store_dwordx4 v[204:207], v22, s[48:51], s78 offen offset:3072
    v_mfma_f32_16x16x32_bf16 v[64:67], v[32:35], v[188:191], v[64:67]
    ds_read_b64_tr_b16 v[56:57], v10 offset:24576
    v_mfma_f32_16x16x32_bf16 v[68:71], v[32:35], v[196:199], v[68:71]
    ds_read_b64_tr_b16 v[58:59], v10 offset:28672
    v_xor_b32 v9, 131072, v9
    v_mfma_f32_16x16x32_bf16 v[72:75], v[32:35], v[204:207], v[72:75]
    s_waitcnt lgkmcnt(10)
    v_mfma_f32_16x16x32_bf16 v[76:79], v[36:39], v[188:191], v[76:79]
    ds_read_b64_tr_b16 v[60:61], v11 offset:24576
    v_mfma_f32_16x16x32_bf16 v[80:83], v[36:39], v[196:199], v[80:83]
    ds_read_b64_tr_b16 v[62:63], v11 offset:28672
    v_xor_b32 v10, 131072, v10
    v_mfma_f32_16x16x32_bf16 v[84:87], v[36:39], v[204:207], v[84:87]
    s_waitcnt lgkmcnt(10)
    s_barrier
    v_mfma_f32_16x16x32_bf16 v[88:91], v[40:43], v[188:191], v[88:91]
    ds_read_b64_tr_b16 v[32:33], v4 offset:0
    v_mfma_f32_16x16x32_bf16 v[92:95], v[40:43], v[196:199], v[92:95]
    ds_read_b64_tr_b16 v[34:35], v4 offset:4096
    v_xor_b32 v11, 131072, v11
    v_mfma_f32_16x16x32_bf16 v[96:99], v[40:43], v[204:207], v[96:99]
    s_waitcnt lgkmcnt(10)
    ds_read_b128 v[208:211], v12 offset:0
    v_mfma_f32_16x16x32_bf16 v[100:103], v[44:47], v[188:191], v[100:103]
    ds_read_b64_tr_b16 v[36:37], v5 offset:0
    v_mfma_f32_16x16x32_bf16 v[104:107], v[44:47], v[196:199], v[104:107]
    ds_read_b64_tr_b16 v[38:39], v5 offset:4096
    v_mfma_f32_16x16x32_bf16 v[108:111], v[44:47], v[204:207], v[108:111]
    s_waitcnt lgkmcnt(11)
    ds_read_b128 v[212:215], v12 offset:2048
    v_mfma_f32_16x16x32_bf16 v[112:115], v[48:51], v[188:191], v[112:115]
    ds_read_b64_tr_b16 v[40:41], v6 offset:0
    v_mfma_f32_16x16x32_bf16 v[116:119], v[48:51], v[196:199], v[116:119]
    ds_read_b64_tr_b16 v[42:43], v6 offset:4096
    v_mfma_f32_16x16x32_bf16 v[120:123], v[48:51], v[204:207], v[120:123]
    s_waitcnt lgkmcnt(12)
    ds_read_b128 v[216:219], v12 offset:4096
    v_mfma_f32_16x16x32_bf16 v[124:127], v[52:55], v[188:191], v[124:127]
    ds_read_b64_tr_b16 v[44:45], v7 offset:0
    v_mfma_f32_16x16x32_bf16 v[128:131], v[52:55], v[196:199], v[128:131]
    ds_read_b64_tr_b16 v[46:47], v7 offset:4096
    v_mfma_f32_16x16x32_bf16 v[132:135], v[52:55], v[204:207], v[132:135]
    s_waitcnt lgkmcnt(13)
    v_mfma_f32_16x16x32_bf16 v[136:139], v[56:59], v[188:191], v[136:139]
    ds_read_b64_tr_b16 v[48:49], v8 offset:0
    v_mov_b32 v3, 2
    v_mfma_f32_16x16x32_bf16 v[140:143], v[56:59], v[196:199], v[140:143]
    ds_read_b64_tr_b16 v[50:51], v8 offset:4096
    v_mfma_f32_16x16x32_bf16 v[144:147], v[56:59], v[204:207], v[144:147]
    s_waitcnt lgkmcnt(13)
    v_mfma_f32_16x16x32_bf16 v[148:151], v[60:63], v[188:191], v[148:151]
    ds_read_b64_tr_b16 v[52:53], v9 offset:0
    v_mfma_f32_16x16x32_bf16 v[152:155], v[60:63], v[196:199], v[152:155]
    ds_read_b64_tr_b16 v[54:55], v9 offset:4096
    v_mfma_f32_16x16x32_bf16 v[156:159], v[60:63], v[204:207], v[156:159]
    s_waitcnt lgkmcnt(12)
    s_branch L_gemm
L_cv_far:
    buffer_store_dwordx4 v[160:163], v22, s[48:51], s76 offen offset:0 sc1
    buffer_store_dwordx4 v[164:167], v22, s[48:51], s76 offen offset:1024 sc1
    buffer_store_dwordx4 v[168:171], v22, s[48:51], s76 offen offset:2048 sc1
    buffer_store_dwordx4 v[172:175], v22, s[48:51], s76 offen offset:3072 sc1
    buffer_store_dwordx4 v[176:179], v22, s[48:51], s63 offen offset:0 sc1
    buffer_store_dwordx4 v[180:183], v22, s[48:51], s63 offen offset:1024 sc1
    buffer_store_dwordx4 v[184:187], v22, s[48:51], s63 offen offset:2048 sc1
    buffer_store_dwordx4 v[188:191], v22, s[48:51], s63 offen offset:3072 sc1
    buffer_store_dwordx4 v[192:195], v22, s[48:51], s78 offen offset:0 sc1
    buffer_store_dwordx4 v[196:199], v22, s[48:51], s78 offen offset:1024 sc1
    buffer_store_dwordx4 v[200:203], v22, s[48:51], s78 offen offset:2048 sc1
    buffer_store_dwordx4 v[204:207], v22, s[48:51], s78 offen offset:3072 sc1
    s_branch L_cv_done
L_f0_far:
    s_mov_b64 exec, 1
    s_waitcnt vmcnt(0)
    buffer_store_dword v3, v2, s[48:51], s64 offen sc1
    s_mov_b64 exec, -1
    s_branch L_f0_done
L_f1_far:
    s_mov_b64 exec, 1
    s_waitcnt vmcnt(0)
    buffer_store_dword v3, v2, s[48:51], s64 offen sc1
    s_mov_b64 exec, -1
    s_branch L_f1_done
L_flag1:
    s_cmp_eq_u32 s61, 0
    s_cbranch_scc1 L_count
    s_cmp_eq_u32 s71, 1
    s_cbranch_scc1 L_f1_far
    s_mov_b64 exec, 1
    s_waitcnt vmcnt(0)
    buffer_store_dword v3, v2, s[48:51], s64 offen
    s_mov_b64 exec, -1
L_f1_done:
    s_branch L_flag1_ret
L_count:
    s_getreg_b32 s64, hwreg(HW_REG_XCC_ID, 0, 3)
    s_mul_i32 s63, s64, s64
    s_lshl_b32 s63, s63, 8
    s_add_u32 s63, s63, s64
    s_lshl_b32 s63, s63, 8
    s_add_u32 s63, s63, 1
    s_and_b32 s64, s2, 7
    s_lshl3_add_u32 s64, s56, s64
    s_lshl_b32 s64, s64, 3
    v_mov_b32 v3, s63
    s_mov_b64 exec, 1
    s_waitcnt vmcnt(0)
    buffer_atomic_add v3, v2, s[72:75], s64 offen sc1
    s_mov_b64 exec, -1
    s_branch L_flag1_ret
L_final:
    v_mfma_f32_16x16x32_bf16 v[64:67], v[32:35], v[208:211], v[64:67]
    s_waitcnt lgkmcnt(9)
    ds_read_b64_tr_b16 v[56:57], v10 offset:0
    v_mfma_f32_16x16x32_bf16 v[68:71], v[32:35], v[212:215], v[68:71]
    s_waitcnt lgkmcnt(7)
    ds_read_b64_tr_b16 v[58:59], v10 offset:4096
    v_mfma_f32_16x16x32_bf16 v[72:75], v[32:35], v[216:219], v[72:75]
    v_mfma_f32_16x16x32_bf16 v[76:79], v[36:39], v[208:211], v[76:79]
    ds_read_b64_tr_b16 v[60:61], v11 offset:0
    v_mfma_f32_16x16x32_bf16 v[80:83], v[36:39], v[212:215], v[80:83]
    ds_read_b64_tr_b16 v[62:63], v11 offset:4096
    v_mfma_f32_16x16x32_bf16 v[84:87], v[36:39], v[216:219], v[84:87]
    v_mfma_f32_16x16x32_bf16 v[88:91], v[40:43], v[208:211], v[88:91]
    ds_read_b64_tr_b16 v[32:33], v6 offset:8192
    v_mfma_f32_16x16x32_bf16 v[92:95], v[40:43], v[212:215], v[92:95]
    ds_read_b64_tr_b16 v[34:35], v6 offset:12288
    v_mfma_f32_16x16x32_bf16 v[96:99], v[40:43], v[216:219], v[96:99]
    s_waitcnt lgkmcnt(10)
    ds_read_b128 v[220:223], v13 offset:0
    v_mfma_f32_16x16x32_bf16 v[100:103], v[44:47], v[208:211], v[100:103]
    ds_read_b64_tr_b16 v[36:37], v7 offset:8192
    v_mfma_f32_16x16x32_bf16 v[104:107], v[44:47], v[212:215], v[104:107]
    ds_read_b64_tr_b16 v[38:39], v7 offset:12288
    v_mfma_f32_16x16x32_bf16 v[108:111], v[44:47], v[216:219], v[108:111]
    s_waitcnt lgkmcnt(11)
    ds_read_b128 v[224:227], v13 offset:2048
    v_mfma_f32_16x16x32_bf16 v[112:115], v[48:51], v[208:211], v[112:115]
    ds_read_b64_tr_b16 v[40:41], v8 offset:8192
    v_mfma_f32_16x16x32_bf16 v[116:119], v[48:51], v[212:215], v[116:119]
    ds_read_b64_tr_b16 v[42:43], v8 offset:12288
    v_mfma_f32_16x16x32_bf16 v[120:123], v[48:51], v[216:219], v[120:123]
    s_waitcnt lgkmcnt(12)
    ds_read_b128 v[228:231], v13 offset:4096
    v_mfma_f32_16x16x32_bf16 v[124:127], v[52:55], v[208:211], v[124:127]
    ds_read_b64_tr_b16 v[44:45], v9 offset:8192
    v_mfma_f32_16x16x32_bf16 v[128:131], v[52:55], v[212:215], v[128:131]
    ds_read_b64_tr_b16 v[46:47], v9 offset:12288
    v_mfma_f32_16x16x32_bf16 v[132:135], v[52:55], v[216:219], v[132:135]
    s_waitcnt lgkmcnt(13)
    v_mfma_f32_16x16x32_bf16 v[136:139], v[56:59], v[208:211], v[136:139]
    ds_read_b64_tr_b16 v[48:49], v10 offset:8192
    v_mfma_f32_16x16x32_bf16 v[140:143], v[56:59], v[212:215], v[140:143]
    ds_read_b64_tr_b16 v[50:51], v10 offset:12288
    v_mfma_f32_16x16x32_bf16 v[144:147], v[56:59], v[216:219], v[144:147]
    s_waitcnt lgkmcnt(13)
    s_lshl_b32 s57, s53, 2
    v_mfma_f32_16x16x32_bf16 v[148:151], v[60:63], v[208:211], v[148:151]
    ds_read_b64_tr_b16 v[52:53], v11 offset:8192
    s_add_u32 s57, s57, s56
    v_mfma_f32_16x16x32_bf16 v[152:155], v[60:63], v[212:215], v[152:155]
    ds_read_b64_tr_b16 v[54:55], v11 offset:12288
    s_lshl_b32 s57, s57, 3
    v_mfma_f32_16x16x32_bf16 v[156:159], v[60:63], v[216:219], v[156:159]
    s_waitcnt lgkmcnt(12)
    s_barrier
    s_add_u32 s57, s57, s67
    v_mfma_f32_16x16x32_bf16 v[88:91], v[32:35], v[220:223], v[88:91]
    s_waitcnt lgkmcnt(9)
    ds_read_b64_tr_b16 v[56:57], v6 offset:40960
    s_mul_i32 s57, s57, 147456
    v_mfma_f32_16x16x32_bf16 v[92:95], v[32:35], v[224:227], v[92:95]
    s_waitcnt lgkmcnt(7)
    ds_read_b64_tr_b16 v[58:59], v6 offset:45056
    s_mul_i32 s58, s52, 3072
    v_mfma_f32_16x16x32_bf16 v[96:99], v[32:35], v[228:231], v[96:99]
    ds_read_b128 v[232:235], v12 offset:40960
    s_add_u32 s57, s57, s58
    v_mfma_f32_16x16x32_bf16 v[100:103], v[36:39], v[220:223], v[100:103]
    ds_read_b64_tr_b16 v[60:61], v7 offset:40960
    s_add_u32 s64, s57, 16777216
    v_mfma_f32_16x16x32_bf16 v[104:107], v[36:39], v[224:227], v[104:107]
    ds_read_b64_tr_b16 v[62:63], v7 offset:45056
    s_xor_b32 s57, s54, 1
    v_mfma_f32_16x16x32_bf16 v[108:111], v[36:39], v[228:231], v[108:111]
    ds_read_b128 v[236:239], v12 offset:43008
    s_mul_i32 s57, s57, 36864
    v_mfma_f32_16x16x32_bf16 v[112:115], v[40:43], v[220:223], v[112:115]
    ds_read_b64_tr_b16 v[32:33], v8 offset:40960
    s_add_u32 s57, s57, 0
    v_mfma_f32_16x16x32_bf16 v[116:119], v[40:43], v[224:227], v[116:119]
    ds_read_b64_tr_b16 v[34:35], v8 offset:45056
    s_add_u32 s76, s57, s64
    v_mfma_f32_16x16x32_bf16 v[120:123], v[40:43], v[228:231], v[120:123]
    s_waitcnt lgkmcnt(12)
    ds_read_b128 v[240:243], v12 offset:45056
    v_add_u32 v12, 4294885376, v12
    s_xor_b32 s57, s54, 2
    v_mfma_f32_16x16x32_bf16 v[124:127], v[44:47], v[220:223], v[124:127]
    ds_read_b64_tr_b16 v[36:37], v9 offset:40960
    s_mul_i32 s57, s57, 36864
    v_mfma_f32_16x16x32_bf16 v[128:131], v[44:47], v[224:227], v[128:131]
    ds_read_b64_tr_b16 v[38:39], v9 offset:45056
    s_add_u32 s57, s57, 12288
    v_mfma_f32_16x16x32_bf16 v[132:135], v[44:47], v[228:231], v[132:135]
    s_waitcnt lgkmcnt(13)
    s_add_u32 s77, s57, s64
    v_mfma_f32_16x16x32_bf16 v[136:139], v[48:51], v[220:223], v[136:139]
    ds_read_b64_tr_b16 v[40:41], v10 offset:40960
    s_xor_b32 s57, s54, 3
    v_mfma_f32_16x16x32_bf16 v[140:143], v[48:51], v[224:227], v[140:143]
    ds_read_b64_tr_b16 v[42:43], v10 offset:45056
    s_mul_i32 s57, s57, 36864
    v_mfma_f32_16x16x32_bf16 v[144:147], v[48:51], v[228:231], v[144:147]
    s_waitcnt lgkmcnt(13)
    s_add_u32 s57, s57, 24576
    v_mfma_f32_16x16x32_bf16 v[148:151], v[52:55], v[220:223], v[148:151]
    ds_read_b64_tr_b16 v[44:45], v11 offset:40960
    s_add_u32 s78, s57, s64
    v_mfma_f32_16x16x32_bf16 v[152:155], v[52:55], v[224:227], v[152:155]
    ds_read_b64_tr_b16 v[46:47], v11 offset:45056
    v_lshlrev_b32 v2, 4, v1
    v_mfma_f32_16x16x32_bf16 v[156:159], v[52:55], v[228:231], v[156:159]
    s_waitcnt lgkmcnt(12)
    v_mfma_f32_16x16x32_bf16 v[88:91], v[56:59], v[232:235], v[88:91]
    s_waitcnt lgkmcnt(9)
    ds_read_b64_tr_b16 v[48:49], v6 offset:49152
    v_mfma_f32_16x16x32_bf16 v[92:95], v[56:59], v[236:239], v[92:95]
    s_waitcnt lgkmcnt(7)
    ds_read_b64_tr_b16 v[50:51], v6 offset:53248
    v_add_u32 v6, 4294885376, v6
    v_mfma_f32_16x16x32_bf16 v[96:99], v[56:59], v[240:243], v[96:99]
    ds_read_b128 v[244:247], v13 offset:40960
    v_mfma_f32_16x16x32_bf16 v[100:103], v[60:63], v[232:235], v[100:103]
    ds_read_b64_tr_b16 v[52:53], v7 offset:49152
    v_mfma_f32_16x16x32_bf16 v[104:107], v[60:63], v[236:239], v[104:107]
    ds_read_b64_tr_b16 v[54:55], v7 offset:53248
    v_add_u32 v7, 4294885376, v7
    v_mfma_f32_16x16x32_bf16 v[108:111], v[60:63], v[240:243], v[108:111]
    ds_read_b128 v[248:251], v13 offset:43008
    v_mfma_f32_16x16x32_bf16 v[112:115], v[32:35], v[232:235], v[112:115]
    ds_read_b64_tr_b16 v[56:57], v8 offset:49152
    v_mfma_f32_16x16x32_bf16 v[116:119], v[32:35], v[236:239], v[116:119]
    ds_read_b64_tr_b16 v[58:59], v8 offset:53248
    v_add_u32 v8, 4294885376, v8
    v_mfma_f32_16x16x32_bf16 v[120:123], v[32:35], v[240:243], v[120:123]
    s_waitcnt lgkmcnt(12)
    ds_read_b128 v[252:255], v13 offset:45056
    v_add_u32 v13, 4294885376, v13
    v_mfma_f32_16x16x32_bf16 v[124:127], v[36:39], v[232:235], v[124:127]
    ds_read_b64_tr_b16 v[60:61], v9 offset:49152
    v_mfma_f32_16x16x32_bf16 v[128:131], v[36:39], v[236:239], v[128:131]
    ds_read_b64_tr_b16 v[62:63], v9 offset:53248
    v_add_u32 v9, 4294885376, v9
    v_mfma_f32_16x16x32_bf16 v[132:135], v[36:39], v[240:243], v[132:135]
    s_waitcnt lgkmcnt(13)
    v_mfma_f32_16x16x32_bf16 v[136:139], v[40:43], v[232:235], v[136:139]
    ds_read_b64_tr_b16 v[32:33], v10 offset:49152
    v_mfma_f32_16x16x32_bf16 v[140:143], v[40:43], v[236:239], v[140:143]
    ds_read_b64_tr_b16 v[34:35], v10 offset:53248
    v_add_u32 v10, 4294885376, v10
    v_mfma_f32_16x16x32_bf16 v[144:147], v[40:43], v[240:243], v[144:147]
    s_waitcnt lgkmcnt(13)
    v_mfma_f32_16x16x32_bf16 v[148:151], v[44:47], v[232:235], v[148:151]
    ds_read_b64_tr_b16 v[36:37], v11 offset:49152
    v_mfma_f32_16x16x32_bf16 v[152:155], v[44:47], v[236:239], v[152:155]
    ds_read_b64_tr_b16 v[38:39], v11 offset:53248
    v_add_u32 v11, 4294885376, v11
    v_mfma_f32_16x16x32_bf16 v[156:159], v[44:47], v[240:243], v[156:159]
    s_waitcnt lgkmcnt(12)
    s_barrier
    v_mfma_f32_16x16x32_bf16 v[88:91], v[48:51], v[244:247], v[88:91]
    s_waitcnt lgkmcnt(9)
    ds_read_b64_tr_b16 v[40:41], v6 offset:0
    v_mfma_f32_16x16x32_bf16 v[92:95], v[48:51], v[248:251], v[92:95]
    s_waitcnt lgkmcnt(7)
    ds_read_b64_tr_b16 v[42:43], v6 offset:4096
    v_mfma_f32_16x16x32_bf16 v[96:99], v[48:51], v[252:255], v[96:99]
    ds_read_b128 v[208:211], v12 offset:0
    v_mfma_f32_16x16x32_bf16 v[100:103], v[52:55], v[244:247], v[100:103]
    ds_read_b64_tr_b16 v[44:45], v7 offset:0
    v_mfma_f32_16x16x32_bf16 v[104:107], v[52:55], v[248:251], v[104:107]
    ds_read_b64_tr_b16 v[46:47], v7 offset:4096
    v_mfma_f32_16x16x32_bf16 v[108:111], v[52:55], v[252:255], v[108:111]
    ds_read_b128 v[212:215], v12 offset:2048
    v_mfma_f32_16x16x32_bf16 v[112:115], v[56:59], v[244:247], v[112:115]
    ds_read_b64_tr_b16 v[48:49], v8 offset:0
    v_mfma_f32_16x16x32_bf16 v[116:119], v[56:59], v[248:251], v[116:119]
    ds_read_b64_tr_b16 v[50:51], v8 offset:4096
    v_mfma_f32_16x16x32_bf16 v[120:123], v[56:59], v[252:255], v[120:123]
    s_waitcnt lgkmcnt(12)
    ds_read_b128 v[216:219], v12 offset:4096
    v_mfma_f32_16x16x32_bf16 v[124:127], v[60:63], v[244:247], v[124:127]
    ds_read_b64_tr_b16 v[52:53], v9 offset:0
    v_mfma_f32_16x16x32_bf16 v[128:131], v[60:63], v[248:251], v[128:131]
    ds_read_b64_tr_b16 v[54:55], v9 offset:4096
    v_mfma_f32_16x16x32_bf16 v[132:135], v[60:63], v[252:255], v[132:135]
    s_waitcnt lgkmcnt(13)
    v_mfma_f32_16x16x32_bf16 v[136:139], v[32:35], v[244:247], v[136:139]
    ds_read_b64_tr_b16 v[56:57], v10 offset:0
    v_mfma_f32_16x16x32_bf16 v[140:143], v[32:35], v[248:251], v[140:143]
    ds_read_b64_tr_b16 v[58:59], v10 offset:4096
    v_mfma_f32_16x16x32_bf16 v[144:147], v[32:35], v[252:255], v[144:147]
    s_waitcnt lgkmcnt(13)
    v_mfma_f32_16x16x32_bf16 v[148:151], v[36:39], v[244:247], v[148:151]
    ds_read_b64_tr_b16 v[60:61], v11 offset:0
    v_mfma_f32_16x16x32_bf16 v[152:155], v[36:39], v[248:251], v[152:155]
    ds_read_b64_tr_b16 v[62:63], v11 offset:4096
    v_mfma_f32_16x16x32_bf16 v[156:159], v[36:39], v[252:255], v[156:159]
    s_waitcnt lgkmcnt(12)
    v_mfma_f32_16x16x32_bf16 v[88:91], v[40:43], v[208:211], v[88:91]
    s_waitcnt lgkmcnt(9)
    ds_read_b64_tr_b16 v[32:33], v6 offset:8192
    v_mfma_f32_16x16x32_bf16 v[92:95], v[40:43], v[212:215], v[92:95]
    s_waitcnt lgkmcnt(7)
    ds_read_b64_tr_b16 v[34:35], v6 offset:12288
    v_mfma_f32_16x16x32_bf16 v[96:99], v[40:43], v[216:219], v[96:99]
    ds_read_b128 v[220:223], v13 offset:0
    v_mfma_f32_16x16x32_bf16 v[100:103], v[44:47], v[208:211], v[100:103]
    ds_read_b64_tr_b16 v[36:37], v7 offset:8192
    v_mfma_f32_16x16x32_bf16 v[104:107], v[44:47], v[212:215], v[104:107]
    ds_read_b64_tr_b16 v[38:39], v7 offset:12288
    v_mfma_f32_16x16x32_bf16 v[108:111], v[44:47], v[216:219], v[108:111]
    ds_read_b128 v[224:227], v13 offset:2048
    v_mfma_f32_16x16x32_bf16 v[112:115], v[48:51], v[208:211], v[112:115]
    ds_read_b64_tr_b16 v[40:41], v8 offset:8192
    v_mfma_f32_16x16x32_bf16 v[116:119], v[48:51], v[212:215], v[116:119]
    ds_read_b64_tr_b16 v[42:43], v8 offset:12288
    v_mfma_f32_16x16x32_bf16 v[120:123], v[48:51], v[216:219], v[120:123]
    s_waitcnt lgkmcnt(12)
    ds_read_b128 v[228:231], v13 offset:4096
    v_mfma_f32_16x16x32_bf16 v[124:127], v[52:55], v[208:211], v[124:127]
    ds_read_b64_tr_b16 v[44:45], v9 offset:8192
    v_mfma_f32_16x16x32_bf16 v[128:131], v[52:55], v[212:215], v[128:131]
    ds_read_b64_tr_b16 v[46:47], v9 offset:12288
    v_mfma_f32_16x16x32_bf16 v[132:135], v[52:55], v[216:219], v[132:135]
    s_waitcnt lgkmcnt(13)
    v_mfma_f32_16x16x32_bf16 v[136:139], v[56:59], v[208:211], v[136:139]
    ds_read_b64_tr_b16 v[48:49], v10 offset:8192
    v_mfma_f32_16x16x32_bf16 v[140:143], v[56:59], v[212:215], v[140:143]
    ds_read_b64_tr_b16 v[50:51], v10 offset:12288
    v_mfma_f32_16x16x32_bf16 v[144:147], v[56:59], v[216:219], v[144:147]
    s_waitcnt lgkmcnt(13)
    v_mfma_f32_16x16x32_bf16 v[148:151], v[60:63], v[208:211], v[148:151]
    ds_read_b64_tr_b16 v[52:53], v11 offset:8192
    v_mfma_f32_16x16x32_bf16 v[152:155], v[60:63], v[212:215], v[152:155]
    ds_read_b64_tr_b16 v[54:55], v11 offset:12288
    v_mfma_f32_16x16x32_bf16 v[156:159], v[60:63], v[216:219], v[156:159]
    s_waitcnt lgkmcnt(12)
    s_barrier
    v_mfma_f32_16x16x32_bf16 v[88:91], v[32:35], v[220:223], v[88:91]
    s_waitcnt lgkmcnt(9)
    ds_read_b64_tr_b16 v[56:57], v6 offset:40960
    v_mfma_f32_16x16x32_bf16 v[92:95], v[32:35], v[224:227], v[92:95]
    s_waitcnt lgkmcnt(7)
    ds_read_b64_tr_b16 v[58:59], v6 offset:45056
    v_mfma_f32_16x16x32_bf16 v[96:99], v[32:35], v[228:231], v[96:99]
    ds_read_b128 v[232:235], v12 offset:40960
    v_mfma_f32_16x16x32_bf16 v[100:103], v[36:39], v[220:223], v[100:103]
    ds_read_b64_tr_b16 v[60:61], v7 offset:40960
    v_mfma_f32_16x16x32_bf16 v[104:107], v[36:39], v[224:227], v[104:107]
    ds_read_b64_tr_b16 v[62:63], v7 offset:45056
    v_mfma_f32_16x16x32_bf16 v[108:111], v[36:39], v[228:231], v[108:111]
    ds_read_b128 v[236:239], v12 offset:43008
    v_mfma_f32_16x16x32_bf16 v[112:115], v[40:43], v[220:223], v[112:115]
    ds_read_b64_tr_b16 v[32:33], v8 offset:40960
    v_mfma_f32_16x16x32_bf16 v[116:119], v[40:43], v[224:227], v[116:119]
    ds_read_b64_tr_b16 v[34:35], v8 offset:45056
    v_mfma_f32_16x16x32_bf16 v[120:123], v[40:43], v[228:231], v[120:123]
    s_waitcnt lgkmcnt(12)
    ds_read_b128 v[240:243], v12 offset:45056
    v_add_u32 v12, 81920, v12
    v_mfma_f32_16x16x32_bf16 v[124:127], v[44:47], v[220:223], v[124:127]
    ds_read_b64_tr_b16 v[36:37], v9 offset:40960
    v_mfma_f32_16x16x32_bf16 v[128:131], v[44:47], v[224:227], v[128:131]
    ds_read_b64_tr_b16 v[38:39], v9 offset:45056
    v_mfma_f32_16x16x32_bf16 v[132:135], v[44:47], v[228:231], v[132:135]
    s_waitcnt lgkmcnt(13)
    v_mfma_f32_16x16x32_bf16 v[136:139], v[48:51], v[220:223], v[136:139]
    ds_read_b64_tr_b16 v[40:41], v10 offset:40960
    v_mfma_f32_16x16x32_bf16 v[140:143], v[48:51], v[224:227], v[140:143]
    ds_read_b64_tr_b16 v[42:43], v10 offset:45056
    v_mfma_f32_16x16x32_bf16 v[144:147], v[48:51], v[228:231], v[144:147]
    s_waitcnt lgkmcnt(13)
    v_mfma_f32_16x16x32_bf16 v[148:151], v[52:55], v[220:223], v[148:151]
    ds_read_b64_tr_b16 v[44:45], v11 offset:40960
    v_mfma_f32_16x16x32_bf16 v[152:155], v[52:55], v[224:227], v[152:155]
    ds_read_b64_tr_b16 v[46:47], v11 offset:45056
    v_mfma_f32_16x16x32_bf16 v[156:159], v[52:55], v[228:231], v[156:159]
    s_waitcnt lgkmcnt(12)
    v_mfma_f32_16x16x32_bf16 v[88:91], v[56:59], v[232:235], v[88:91]
    s_waitcnt lgkmcnt(9)
    ds_read_b64_tr_b16 v[48:49], v6 offset:49152
    v_mfma_f32_16x16x32_bf16 v[92:95], v[56:59], v[236:239], v[92:95]
    s_waitcnt lgkmcnt(7)
    ds_read_b64_tr_b16 v[50:51], v6 offset:53248
    v_mfma_f32_16x16x32_bf16 v[96:99], v[56:59], v[240:243], v[96:99]
    ds_read_b128 v[244:247], v13 offset:40960
    v_mfma_f32_16x16x32_bf16 v[100:103], v[60:63], v[232:235], v[100:103]
    ds_read_b64_tr_b16 v[52:53], v7 offset:49152
    v_mfma_f32_16x16x32_bf16 v[104:107], v[60:63], v[236:239], v[104:107]
    ds_read_b64_tr_b16 v[54:55], v7 offset:53248
    v_mfma_f32_16x16x32_bf16 v[108:111], v[60:63], v[240:243], v[108:111]
    ds_read_b128 v[248:251], v13 offset:43008
    v_mfma_f32_16x16x32_bf16 v[112:115], v[32:35], v[232:235], v[112:115]
    ds_read_b64_tr_b16 v[56:57], v8 offset:49152
    v_mfma_f32_16x16x32_bf16 v[116:119], v[32:35], v[236:239], v[116:119]
    ds_read_b64_tr_b16 v[58:59], v8 offset:53248
    v_mfma_f32_16x16x32_bf16 v[120:123], v[32:35], v[240:243], v[120:123]
    s_waitcnt lgkmcnt(12)
    ds_read_b128 v[252:255], v13 offset:45056
    v_add_u32 v13, 81920, v13
    v_mfma_f32_16x16x32_bf16 v[124:127], v[36:39], v[232:235], v[124:127]
    ds_read_b64_tr_b16 v[60:61], v9 offset:49152
    v_mfma_f32_16x16x32_bf16 v[128:131], v[36:39], v[236:239], v[128:131]
    ds_read_b64_tr_b16 v[62:63], v9 offset:53248
    v_mfma_f32_16x16x32_bf16 v[132:135], v[36:39], v[240:243], v[132:135]
    s_waitcnt lgkmcnt(13)
    v_mfma_f32_16x16x32_bf16 v[136:139], v[40:43], v[232:235], v[136:139]
    ds_read_b64_tr_b16 v[32:33], v10 offset:49152
    v_mfma_f32_16x16x32_bf16 v[140:143], v[40:43], v[236:239], v[140:143]
    ds_read_b64_tr_b16 v[34:35], v10 offset:53248
    v_mfma_f32_16x16x32_bf16 v[144:147], v[40:43], v[240:243], v[144:147]
    s_waitcnt lgkmcnt(13)
    v_mfma_f32_16x16x32_bf16 v[148:151], v[44:47], v[232:235], v[148:151]
    ds_read_b64_tr_b16 v[36:37], v11 offset:49152
    v_mfma_f32_16x16x32_bf16 v[152:155], v[44:47], v[236:239], v[152:155]
    ds_read_b64_tr_b16 v[38:39], v11 offset:53248
    v_mfma_f32_16x16x32_bf16 v[156:159], v[44:47], v[240:243], v[156:159]
    s_waitcnt lgkmcnt(12)
    v_mfma_f32_16x16x32_bf16 v[88:91], v[48:51], v[244:247], v[88:91]
    s_waitcnt lgkmcnt(9)
    ds_read_b64_tr_b16 v[40:41], v4 offset:8192
    v_mfma_f32_16x16x32_bf16 v[92:95], v[48:51], v[248:251], v[92:95]
    s_waitcnt lgkmcnt(7)
    ds_read_b64_tr_b16 v[42:43], v4 offset:12288
    v_mfma_f32_16x16x32_bf16 v[96:99], v[48:51], v[252:255], v[96:99]
    ds_read_b128 v[208:211], v13 offset:0
    ds_read_b128 v[212:215], v13 offset:2048
    v_mfma_f32_16x16x32_bf16 v[100:103], v[52:55], v[244:247], v[100:103]
    ds_read_b64_tr_b16 v[44:45], v5 offset:8192
    v_mfma_f32_16x16x32_bf16 v[104:107], v[52:55], v[248:251], v[104:107]
    ds_read_b64_tr_b16 v[46:47], v5 offset:12288
    v_mfma_f32_16x16x32_bf16 v[108:111], v[52:55], v[252:255], v[108:111]
    ds_read_b128 v[216:219], v13 offset:4096
    v_mfma_f32_16x16x32_bf16 v[112:115], v[56:59], v[244:247], v[112:115]
    ds_read_b64_tr_b16 v[48:49], v4 offset:40960
    v_mfma_f32_16x16x32_bf16 v[116:119], v[56:59], v[248:251], v[116:119]
    ds_read_b64_tr_b16 v[50:51], v4 offset:45056
    v_mfma_f32_16x16x32_bf16 v[120:123], v[56:59], v[252:255], v[120:123]
    s_waitcnt lgkmcnt(13)
    ds_read_b128 v[220:223], v12 offset:40960
    ds_read_b128 v[224:227], v12 offset:43008
    v_mfma_f32_16x16x32_bf16 v[124:127], v[60:63], v[244:247], v[124:127]
    s_waitcnt lgkmcnt(14)
    ds_read_b64_tr_b16 v[52:53], v5 offset:40960
    v_mfma_f32_16x16x32_bf16 v[128:131], v[60:63], v[248:251], v[128:131]
    s_waitcnt lgkmcnt(14)
    ds_read_b64_tr_b16 v[54:55], v5 offset:45056
    v_cvt_pk_bf16_f32 v160, v88, v89
    v_cvt_pk_bf16_f32 v161, v90, v91
    v_mfma_f32_16x16x32_bf16 v[132:135], v[60:63], v[252:255], v[132:135]
    s_waitcnt lgkmcnt(14)
    ds_read_b128 v[228:231], v12 offset:45056
    v_add_u32 v12, 4294885376, v12
    v_cvt_pk_bf16_f32 v162, v100, v101
    v_cvt_pk_bf16_f32 v163, v102, v103
    v_mfma_f32_16x16x32_bf16 v[136:139], v[32:35], v[244:247], v[136:139]
    s_waitcnt lgkmcnt(14)
    ds_read_b64_tr_b16 v[56:57], v4 offset:49152
    buffer_store_dwordx4 v[160:163], v2, s[48:51], s76 offen offset:0 sc1
    v_cvt_pk_bf16_f32 v164, v92, v93
    v_mfma_f32_16x16x32_bf16 v[140:143], v[32:35], v[248:251], v[140:143]
    s_waitcnt lgkmcnt(14)
    ds_read_b64_tr_b16 v[58:59], v4 offset:53248
    v_add_u32 v4, 4294885376, v4
    v_cvt_pk_bf16_f32 v165, v94, v95
    v_cvt_pk_bf16_f32 v166, v104, v105
    v_mfma_f32_16x16x32_bf16 v[144:147], v[32:35], v[252:255], v[144:147]
    s_waitcnt lgkmcnt(14)
    ds_read_b128 v[232:235], v13 offset:40960
    s_waitcnt lgkmcnt(14)
    ds_read_b128 v[236:239], v13 offset:43008
    v_cvt_pk_bf16_f32 v167, v106, v107
    buffer_store_dwordx4 v[164:167], v2, s[48:51], s76 offen offset:1024 sc1
    v_mfma_f32_16x16x32_bf16 v[148:151], v[36:39], v[244:247], v[148:151]
    s_waitcnt lgkmcnt(14)
    ds_read_b64_tr_b16 v[60:61], v5 offset:49152
    v_cvt_pk_bf16_f32 v168, v96, v97
    v_cvt_pk_bf16_f32 v169, v98, v99
    v_mfma_f32_16x16x32_bf16 v[152:155], v[36:39], v[248:251], v[152:155]
    s_waitcnt lgkmcnt(14)
    ds_read_b64_tr_b16 v[62:63], v5 offset:53248
    v_add_u32 v5, 4294885376, v5
    v_cvt_pk_bf16_f32 v170, v108, v109
    v_cvt_pk_bf16_f32 v171, v110, v111
    v_mfma_f32_16x16x32_bf16 v[156:159], v[36:39], v[252:255], v[156:159]
    s_waitcnt lgkmcnt(14)
    ds_read_b128 v[240:243], v13 offset:45056
    v_add_u32 v13, 4294885376, v13
    buffer_store_dwordx4 v[168:171], v2, s[48:51], s76 offen offset:2048 sc1
    v_cvt_pk_bf16_f32 v172, v112, v113
    v_mfma_f32_16x16x32_bf16 v[64:67], v[40:43], v[208:211], v[64:67]
    s_waitcnt lgkmcnt(14)
    ds_read_b64_tr_b16 v[32:33], v4 offset:0
    v_cvt_pk_bf16_f32 v173, v114, v115
    v_cvt_pk_bf16_f32 v174, v124, v125
    v_mfma_f32_16x16x32_bf16 v[68:71], v[40:43], v[212:215], v[68:71]
    s_waitcnt lgkmcnt(14)
    ds_read_b64_tr_b16 v[34:35], v4 offset:4096
    v_cvt_pk_bf16_f32 v175, v126, v127
    buffer_store_dwordx4 v[172:175], v2, s[48:51], s77 offen offset:0 sc1
    v_mfma_f32_16x16x32_bf16 v[72:75], v[40:43], v[216:219], v[72:75]
    s_waitcnt lgkmcnt(14)
    ds_read_b128 v[244:247], v12 offset:0
    s_waitcnt lgkmcnt(14)
    ds_read_b128 v[248:251], v12 offset:2048
    v_cvt_pk_bf16_f32 v176, v116, v117
    v_cvt_pk_bf16_f32 v177, v118, v119
    v_mfma_f32_16x16x32_bf16 v[76:79], v[44:47], v[208:211], v[76:79]
    s_waitcnt lgkmcnt(14)
    ds_read_b64_tr_b16 v[36:37], v5 offset:0
    v_cvt_pk_bf16_f32 v178, v128, v129
    v_cvt_pk_bf16_f32 v179, v130, v131
    v_mfma_f32_16x16x32_bf16 v[80:83], v[44:47], v[212:215], v[80:83]
    s_waitcnt lgkmcnt(14)
    ds_read_b64_tr_b16 v[38:39], v5 offset:4096
    buffer_store_dwordx4 v[176:179], v2, s[48:51], s77 offen offset:1024 sc1
    v_cvt_pk_bf16_f32 v180, v120, v121
    v_mfma_f32_16x16x32_bf16 v[84:87], v[44:47], v[216:219], v[84:87]
    s_waitcnt lgkmcnt(14)
    ds_read_b128 v[252:255], v12 offset:4096
    v_cvt_pk_bf16_f32 v181, v122, v123
    v_cvt_pk_bf16_f32 v182, v132, v133
    v_mfma_f32_16x16x32_bf16 v[64:67], v[48:51], v[220:223], v[64:67]
    s_waitcnt lgkmcnt(14)
    ds_read_b64_tr_b16 v[40:41], v4 offset:8192
    v_cvt_pk_bf16_f32 v183, v134, v135
    buffer_store_dwordx4 v[180:183], v2, s[48:51], s77 offen offset:2048 sc1
    v_mfma_f32_16x16x32_bf16 v[68:71], v[48:51], v[224:227], v[68:71]
    s_waitcnt lgkmcnt(14)
    ds_read_b64_tr_b16 v[42:43], v4 offset:12288
    v_cvt_pk_bf16_f32 v184, v136, v137
    v_cvt_pk_bf16_f32 v185, v138, v139
    v_mfma_f32_16x16x32_bf16 v[72:75], v[48:51], v[228:231], v[72:75]
    s_waitcnt lgkmcnt(14)
    ds_read_b128 v[208:211], v13 offset:0
    s_waitcnt lgkmcnt(14)
    ds_read_b128 v[212:215], v13 offset:2048
    v_cvt_pk_bf16_f32 v186, v148, v149
    v_cvt_pk_bf16_f32 v187, v150, v151
    v_mfma_f32_16x16x32_bf16 v[76:79], v[52:55], v[220:223], v[76:79]
    s_waitcnt lgkmcnt(14)
    ds_read_b64_tr_b16 v[44:45], v5 offset:8192
    buffer_store_dwordx4 v[184:187], v2, s[48:51], s78 offen offset:0 sc1
    v_cvt_pk_bf16_f32 v188, v140, v141
    v_mfma_f32_16x16x32_bf16 v[80:83], v[52:55], v[224:227], v[80:83]
    s_waitcnt lgkmcnt(14)
    ds_read_b64_tr_b16 v[46:47], v5 offset:12288
    v_cvt_pk_bf16_f32 v189, v142, v143
    v_cvt_pk_bf16_f32 v190, v152, v153
    v_mfma_f32_16x16x32_bf16 v[84:87], v[52:55], v[228:231], v[84:87]
    s_waitcnt lgkmcnt(14)
    ds_read_b128 v[216:219], v13 offset:4096
    v_cvt_pk_bf16_f32 v191, v154, v155
    buffer_store_dwordx4 v[188:191], v2, s[48:51], s78 offen offset:1024 sc1
    v_mfma_f32_16x16x32_bf16 v[64:67], v[56:59], v[232:235], v[64:67]
    s_waitcnt lgkmcnt(14)
    ds_read_b64_tr_b16 v[48:49], v4 offset:40960
    v_cvt_pk_bf16_f32 v192, v144, v145
    v_cvt_pk_bf16_f32 v193, v146, v147
    v_mfma_f32_16x16x32_bf16 v[68:71], v[56:59], v[236:239], v[68:71]
    s_waitcnt lgkmcnt(14)
    ds_read_b64_tr_b16 v[50:51], v4 offset:45056
    v_cvt_pk_bf16_f32 v194, v156, v157
    v_cvt_pk_bf16_f32 v195, v158, v159
    v_mfma_f32_16x16x32_bf16 v[72:75], v[56:59], v[240:243], v[72:75]
    s_waitcnt lgkmcnt(14)
    ds_read_b128 v[220:223], v12 offset:40960
    s_waitcnt lgkmcnt(14)
    ds_read_b128 v[224:227], v12 offset:43008
    buffer_store_dwordx4 v[192:195], v2, s[48:51], s78 offen offset:2048 sc1
    v_mfma_f32_16x16x32_bf16 v[76:79], v[60:63], v[232:235], v[76:79]
    s_waitcnt lgkmcnt(14)
    ds_read_b64_tr_b16 v[52:53], v5 offset:40960
    v_mfma_f32_16x16x32_bf16 v[80:83], v[60:63], v[236:239], v[80:83]
    s_waitcnt lgkmcnt(14)
    ds_read_b64_tr_b16 v[54:55], v5 offset:45056
    v_mfma_f32_16x16x32_bf16 v[84:87], v[60:63], v[240:243], v[84:87]
    s_waitcnt lgkmcnt(14)
    ds_read_b128 v[228:231], v12 offset:45056
    v_mfma_f32_16x16x32_bf16 v[64:67], v[32:35], v[244:247], v[64:67]
    s_waitcnt lgkmcnt(14)
    ds_read_b64_tr_b16 v[56:57], v4 offset:49152
    v_mfma_f32_16x16x32_bf16 v[68:71], v[32:35], v[248:251], v[68:71]
    s_waitcnt lgkmcnt(14)
    ds_read_b64_tr_b16 v[58:59], v4 offset:53248
    v_mfma_f32_16x16x32_bf16 v[72:75], v[32:35], v[252:255], v[72:75]
    s_waitcnt lgkmcnt(14)
    ds_read_b128 v[232:235], v13 offset:40960
    s_waitcnt lgkmcnt(14)
    ds_read_b128 v[236:239], v13 offset:43008
    v_mfma_f32_16x16x32_bf16 v[76:79], v[36:39], v[244:247], v[76:79]
    s_waitcnt lgkmcnt(14)
    ds_read_b64_tr_b16 v[60:61], v5 offset:49152
    v_mfma_f32_16x16x32_bf16 v[80:83], v[36:39], v[248:251], v[80:83]
    s_waitcnt lgkmcnt(14)
    ds_read_b64_tr_b16 v[62:63], v5 offset:53248
    v_mfma_f32_16x16x32_bf16 v[84:87], v[36:39], v[252:255], v[84:87]
    s_waitcnt lgkmcnt(14)
    ds_read_b128 v[240:243], v13 offset:45056
    v_mfma_f32_16x16x32_bf16 v[64:67], v[40:43], v[208:211], v[64:67]
    v_mfma_f32_16x16x32_bf16 v[68:71], v[40:43], v[212:215], v[68:71]
    s_waitcnt lgkmcnt(14)
    v_mfma_f32_16x16x32_bf16 v[72:75], v[40:43], v[216:219], v[72:75]
    v_mfma_f32_16x16x32_bf16 v[76:79], v[44:47], v[208:211], v[76:79]
    v_mfma_f32_16x16x32_bf16 v[80:83], v[44:47], v[212:215], v[80:83]
    v_mfma_f32_16x16x32_bf16 v[84:87], v[44:47], v[216:219], v[84:87]
    s_waitcnt lgkmcnt(11)
    v_mfma_f32_16x16x32_bf16 v[64:67], v[48:51], v[220:223], v[64:67]
    s_waitcnt lgkmcnt(10)
    v_mfma_f32_16x16x32_bf16 v[68:71], v[48:51], v[224:227], v[68:71]
    s_waitcnt lgkmcnt(7)
    v_mfma_f32_16x16x32_bf16 v[72:75], v[48:51], v[228:231], v[72:75]
    v_mfma_f32_16x16x32_bf16 v[76:79], v[52:55], v[220:223], v[76:79]
    v_mfma_f32_16x16x32_bf16 v[80:83], v[52:55], v[224:227], v[80:83]
    v_mfma_f32_16x16x32_bf16 v[84:87], v[52:55], v[228:231], v[84:87]
    s_waitcnt lgkmcnt(4)
    v_mfma_f32_16x16x32_bf16 v[64:67], v[56:59], v[232:235], v[64:67]
    s_waitcnt lgkmcnt(3)
    v_mfma_f32_16x16x32_bf16 v[68:71], v[56:59], v[236:239], v[68:71]
    s_waitcnt lgkmcnt(0)
    v_mfma_f32_16x16x32_bf16 v[72:75], v[56:59], v[240:243], v[72:75]
    v_mfma_f32_16x16x32_bf16 v[76:79], v[60:63], v[232:235], v[76:79]
    v_mfma_f32_16x16x32_bf16 v[80:83], v[60:63], v[236:239], v[80:83]
    v_mfma_f32_16x16x32_bf16 v[84:87], v[60:63], v[240:243], v[84:87]
    v_and_b32 v3, 3, v1
    v_xor_b32 v3, s2, v3
    v_lshlrev_b32 v3, 10, v3
    s_lshl_b32 s58, s52, 7
    s_add_u32 s58, s58, 33554944
    s_mul_i32 s57, s54, 36864
    s_add_u32 s64, s64, s57
    v_mov_b32 v4, 1
    s_mov_b32 s32, s24
    s_and_b32 s33, s25, 0xffff
    s_mov_b32 s34, 3145728
    s_mov_b32 s35, 0x20000
    s_lshl_b32 s57, s56, 2
    s_add_u32 s57, s57, s52
    s_mul_i32 s63, s57, 196608
    s_lshl_b32 s57, s53, 3
    s_add_u32 s57, s57, s67
    s_lshl_b32 s57, s57, 2
    s_add_u32 s57, s57, s54
    s_lshl_b32 s57, s57, 6
    s_add_u32 s63, s63, s57
    s_mul_i32 s57, s52, 6144
    s_add_u32 s57, s57, 16384
    v_and_b32 v7, 15, v1
    v_mul_u32_u24 v7, 80, v7
    v_lshrrev_b32 v8, 4, v1
    v_lshl_add_u32 v7, v8, 3, v7
    v_add_u32 v7, s57, v7
    v_lshrrev_b32 v9, 2, v1
    v_and_b32 v6, 3, v1
    v_lshlrev_b32 v6, 4, v6
    v_mul_u32_u24 v8, 80, v9
    v_add3_u32 v8, v8, v6, s57
    v_lshl_add_u32 v6, v9, 12, v6
    s_mov_b64 exec, 1
    s_waitcnt vmcnt(0)
    buffer_store_dword v4, v3, s[48:51], s58 offen sc1
    s_mov_b32 s57, 0xffff0000
    s_add_u32 s76, s64, 12288
    s_add_u32 s77, s64, 24576
    s_mov_b32 s70, 14
    s_mov_b32 s62, 0
L_poll2:
    s_mov_b64 exec, 14
    buffer_load_dword v5, v3, s[48:51], s58 offen sc1
    s_mov_b64 exec, -1
L_drain:
    s_bitcmp0_b32 s62, 1
    s_cbranch_scc1 L_nu0
    s_waitcnt vmcnt(0)
    v_lshlrev_b32 v88, 16, v208
    v_and_b32 v89, s57, v208
    v_lshlrev_b32 v90, 16, v209
    v_and_b32 v91, s57, v209
    v_lshlrev_b32 v92, 16, v210
    v_and_b32 v93, s57, v210
    v_lshlrev_b32 v94, 16, v211
    v_and_b32 v95, s57, v211
    v_lshlrev_b32 v96, 16, v212
    v_and_b32 v97, s57, v212
    v_lshlrev_b32 v98, 16, v213
    v_and_b32 v99, s57, v213
    v_lshlrev_b32 v100, 16, v214
    v_and_b32 v101, s57, v214
    v_lshlrev_b32 v102, 16, v215
    v_and_b32 v103, s57, v215
    v_lshlrev_b32 v104, 16, v216
    v_and_b32 v105, s57, v216
    v_lshlrev_b32 v106, 16, v217
    v_and_b32 v107, s57, v217
    v_lshlrev_b32 v108, 16, v218
    v_and_b32 v109, s57, v218
    v_lshlrev_b32 v110, 16, v219
    v_and_b32 v111, s57, v219
L_nu0:
    s_bitcmp0_b32 s62, 2
    s_cbranch_scc1 L_nu1
    s_waitcnt vmcnt(0)
    v_lshlrev_b32 v112, 16, v220
    v_and_b32 v113, s57, v220
    v_lshlrev_b32 v114, 16, v221
    v_and_b32 v115, s57, v221
    v_lshlrev_b32 v116, 16, v222
    v_and_b32 v117, s57, v222
    v_lshlrev_b32 v118, 16, v223
    v_and_b32 v119, s57, v223
    v_lshlrev_b32 v120, 16, v224
    v_and_b32 v121, s57, v224
    v_lshlrev_b32 v122, 16, v225
    v_and_b32 v123, s57, v225
    v_lshlrev_b32 v124, 16, v226
    v_and_b32 v125, s57, v226
    v_lshlrev_b32 v126, 16, v227
    v_and_b32 v127, s57, v227
    v_lshlrev_b32 v128, 16, v228
    v_and_b32 v129, s57, v228
    v_lshlrev_b32 v130, 16, v229
    v_and_b32 v131, s57, v229
    v_lshlrev_b32 v132, 16, v230
    v_and_b32 v133, s57, v230
    v_lshlrev_b32 v134, 16, v231
    v_and_b32 v135, s57, v231
L_nu1:
    s_bitcmp0_b32 s62, 3
    s_cbranch_scc1 L_nu2
    s_waitcnt vmcnt(0)
    v_lshlrev_b32 v136, 16, v232
    v_and_b32 v137, s57, v232
    v_lshlrev_b32 v138, 16, v233
    v_and_b32 v139, s57, v233
    v_lshlrev_b32 v140, 16, v234
    v_and_b32 v141, s57, v234
    v_lshlrev_b32 v142, 16, v235
    v_and_b32 v143, s57, v235
    v_lshlrev_b32 v144, 16, v236
    v_and_b32 v145, s57, v236
    v_lshlrev_b32 v146, 16, v237
    v_and_b32 v147, s57, v237
    v_lshlrev_b32 v148, 16, v238
    v_and_b32 v149, s57, v238
    v_lshlrev_b32 v150, 16, v239
    v_and_b32 v151, s57, v239
    v_lshlrev_b32 v152, 16, v240
    v_and_b32 v153, s57, v240
    v_lshlrev_b32 v154, 16, v241
    v_and_b32 v155, s57, v241
    v_lshlrev_b32 v156, 16, v242
    v_and_b32 v157, s57, v242
    v_lshlrev_b32 v158, 16, v243
    v_and_b32 v159, s57, v243
L_nu2:
    s_cmp_eq_u32 s70, 0
    s_cbranch_scc1 L_poll2_done
    s_waitcnt vmcnt(0)
    v_cmp_ne_u32 vcc, 0, v5
    s_sub_u32 s79, s79, 1
    s_cselect_b32 s62, 14, 0
    s_nop 2
    s_or_b32 s62, s62, vcc_lo
    s_and_b32 s62, s62, s70
    s_cbranch_scc0 L_poll2
    s_bitcmp0_b32 s62, 1
    s_cbranch_scc1 L_nl0
    buffer_load_dwordx4 v[208:211], v2, s[48:51], s64 offen offset:0 sc1
    buffer_load_dwordx4 v[212:215], v2, s[48:51], s64 offen offset:1024 sc1
    buffer_load_dwordx4 v[216:219], v2, s[48:51], s64 offen offset:2048 sc1
L_nl0:
    s_bitcmp0_b32 s62, 2
    s_cbranch_scc1 L_nl1
    buffer_load_dwordx4 v[220:223], v2, s[48:51], s76 offen offset:0 sc1
    buffer_load_dwordx4 v[224:227], v2, s[48:51], s76 offen offset:1024 sc1
    buffer_load_dwordx4 v[228:231], v2, s[48:51], s76 offen offset:2048 sc1
L_nl1:
    s_bitcmp0_b32 s62, 3
    s_cbranch_scc1 L_nl2
    buffer_load_dwordx4 v[232:235], v2, s[48:51], s77 offen offset:0 sc1
    buffer_load_dwordx4 v[236:239], v2, s[48:51], s77 offen offset:1024 sc1
    buffer_load_dwordx4 v[240:243], v2, s[48:51], s77 offen offset:2048 sc1
L_nl2:
    s_andn2_b32 s70, s70, s62
    s_cbranch_scc1 L_poll2
    s_branch L_drain
L_poll2_done:
    v_pk_add_f32 v[64:65], v[64:65], v[88:89]
    v_pk_add_f32 v[66:67], v[66:67], v[90:91]
    v_pk_add_f32 v[76:77], v[76:77], v[92:93]
    v_pk_add_f32 v[78:79], v[78:79], v[94:95]
    v_pk_add_f32 v[64:65], v[64:65], v[112:113]
    v_pk_add_f32 v[66:67], v[66:67], v[114:115]
    v_pk_add_f32 v[76:77], v[76:77], v[116:117]
    v_pk_add_f32 v[78:79], v[78:79], v[118:119]
    v_pk_add_f32 v[64:65], v[64:65], v[136:137]
    v_pk_add_f32 v[66:67], v[66:67], v[138:139]
    v_pk_add_f32 v[76:77], v[76:77], v[140:141]
    v_pk_add_f32 v[78:79], v[78:79], v[142:143]
    v_cvt_pk_bf16_f32 v40, v64, v65
    v_cvt_pk_bf16_f32 v41, v66, v67
    v_cvt_pk_bf16_f32 v42, v76, v77
    v_cvt_pk_bf16_f32 v43, v78, v79
    ds_write_b64 v7, v[40:41] offset:0
    ds_write_b64 v7, v[42:43] offset:32
    ds_read_b128 v[40:43], v8 offset:0
    v_pk_add_f32 v[68:69], v[68:69], v[96:97]
    v_pk_add_f32 v[70:71], v[70:71], v[98:99]
    v_pk_add_f32 v[80:81], v[80:81], v[100:101]
    v_pk_add_f32 v[82:83], v[82:83], v[102:103]
    v_pk_add_f32 v[68:69], v[68:69], v[120:121]
    v_pk_add_f32 v[70:71], v[70:71], v[122:123]
    v_pk_add_f32 v[80:81], v[80:81], v[124:125]
    v_pk_add_f32 v[82:83], v[82:83], v[126:127]
    v_pk_add_f32 v[68:69], v[68:69], v[144:145]
    v_pk_add_f32 v[70:71], v[70:71], v[146:147]
    v_pk_add_f32 v[80:81], v[80:81], v[148:149]
    v_pk_add_f32 v[82:83], v[82:83], v[150:151]
    v_cvt_pk_bf16_f32 v44, v68, v69
    v_cvt_pk_bf16_f32 v45, v70, v71
    v_cvt_pk_bf16_f32 v46, v80, v81
    v_cvt_pk_bf16_f32 v47, v82, v83
    ds_write_b64 v7, v[44:45] offset:1280
    ds_write_b64 v7, v[46:47] offset:1312
    ds_read_b128 v[44:47], v8 offset:1280
    v_pk_add_f32 v[72:73], v[72:73], v[104:105]
    v_pk_add_f32 v[74:75], v[74:75], v[106:107]
    v_pk_add_f32 v[84:85], v[84:85], v[108:109]
    v_pk_add_f32 v[86:87], v[86:87], v[110:111]
    v_pk_add_f32 v[72:73], v[72:73], v[128:129]
    v_pk_add_f32 v[74:75], v[74:75], v[130:131]
    v_pk_add_f32 v[84:85], v[84:85], v[132:133]
    v_pk_add_f32 v[86:87], v[86:87], v[134:135]
    v_pk_add_f32 v[72:73], v[72:73], v[152:153]
    v_pk_add_f32 v[74:75], v[74:75], v[154:155]
    v_pk_add_f32 v[84:85], v[84:85], v[156:157]
    v_pk_add_f32 v[86:87], v[86:87], v[158:159]
    v_cvt_pk_bf16_f32 v48, v72, v73
    v_cvt_pk_bf16_f32 v49, v74, v75
    v_cvt_pk_bf16_f32 v50, v84, v85
    v_cvt_pk_bf16_f32 v51, v86, v87
    ds_write_b64 v7, v[48:49] offset:2560
    ds_write_b64 v7, v[50:51] offset:2592
    ds_read_b128 v[48:51], v8 offset:2560
    s_waitcnt lgkmcnt(6)
    buffer_store_dwordx4 v[40:43], v6, s[32:35], s63 offen
    s_add_u32 s63, s63, 65536
    s_waitcnt lgkmcnt(3)
    buffer_store_dwordx4 v[44:47], v6, s[32:35], s63 offen
    s_add_u32 s63, s63, 65536
    s_waitcnt lgkmcnt(0)
    buffer_store_dwordx4 v[48:51], v6, s[32:35], s63 offen
L_last:
    s_endpgm
.section .rodata,"a"
.p2align 6
.amdhsa_kernel concat_heads__mha_block_cached__gqa_block_cached__near_ridge_kernel
  .amdhsa_next_free_vgpr 256
  .amdhsa_next_free_sgpr 102
  .amdhsa_accum_offset 256
  .amdhsa_group_segment_fixed_size 0
  .amdhsa_kernarg_size 104
  .amdhsa_user_sgpr_count 2
  .amdhsa_user_sgpr_kernarg_segment_ptr 1
  .amdhsa_system_sgpr_workgroup_id_x 1
.end_amdhsa_kernel
```
